```python
import torch

def _softmax(x, axis=-1):
    return torch.softmax(x, dim=axis)
def _gelu(x):
    return torch.nn.functional.gelu(x, approximate="tanh")
def _silu(x):
    return torch.nn.functional.silu(x)
def _sigmoid(x):
    return torch.sigmoid(x)
def _layernorm(x, axis=-1, eps=1e-5):
    m = x.mean(dim=axis, keepdim=True)
    v = x.var(dim=axis, keepdim=True, unbiased=False)
    return (x - m) / torch.sqrt(v + eps)
def _scatter_add(tgt, idx, src, axis=0):
    return tgt.clone().index_add_(axis, idx, src)
def _segment_sum(src, seg, n):
    out = torch.zeros((n,) + src.shape[1:], dtype=src.dtype)
    return out.index_add_(0, seg, src)
def _pad(x, pw):
    flat = tuple(v for pair in reversed(pw) for v in pair)
    return torch.nn.functional.pad(x, flat)

kernel_name = 'gather_scatter__hybrid_graph_tf_nagphormer__graph'

def setup_inputs():

    _w = (lambda a: (lambda t: t.to(torch.bfloat16) if t.is_floating_point() else t)(torch.as_tensor(a)))
    N, deg, D = 10000, 16, 128
    E = N * deg
    src = (lambda lo, hi, *s: torch.randint(lo, hi, s))(0, N, E).to(torch.int64)
    dst = (lambda lo, hi, *s: torch.randint(lo, hi, s))(0, N, E).to(torch.int64)
    deg_cnt = torch.bincount(dst, minlength=N).to(float) + 1.0
    sc = 1.0 / D ** 0.5
    return {
        "x": _w((lambda *s: torch.randn(*s, dtype=torch.bfloat16) * 0.1)(N, D)),
        "src": _w(src),
        "dst": _w(dst),
        "deg_inv_sqrt": _w(1.0 / (lambda _x: torch.sqrt(torch.as_tensor(_x)))(deg_cnt)),
        "wq": _w((lambda *s: torch.randn(*s, dtype=torch.bfloat16) * 3.2)(D, D) * sc),
        "wk": _w((lambda *s: torch.randn(*s, dtype=torch.bfloat16) * 3.2)(D, D) * sc),
        "wv": _w((lambda *s: torch.randn(*s, dtype=torch.bfloat16) * 0.1)(D, D) * sc),
        "wo": _w((lambda *s: torch.randn(*s, dtype=torch.bfloat16) * 0.1)(D, D) * sc),
        "w_r": _w((lambda *s: torch.randn(*s, dtype=torch.bfloat16) * 0.1)(D)),
    }

def reference(x, src, dst, deg_inv_sqrt, wq, wk, wv, wo, w_r):
    N, D = x.shape[0], x.shape[1]
    K = 7
    h = x
    toks = [x]
    for _ in range(K):
        msg = h[src] * deg_inv_sqrt[src, None] * deg_inv_sqrt[dst, None]
        h = _segment_sum(msg, dst, N)
        toks.append(h)
    tok = torch.stack(toks, axis=1)
    t = _layernorm(tok, axis=-1)
    q   = torch.einsum('nkd,de->nke', t, wq)
    key = torch.einsum('nkd,de->nke', t, wk)
    v   = torch.einsum('nkd,de->nke', t, wv)
    scale = 1.0 / (D ** 0.5)
    attn = _softmax(torch.einsum('nkd,nld->nkl', q, key) * scale, axis=-1)
    o = torch.einsum('nkl,nld->nkd', attn, v)
    o = tok + torch.einsum('nkd,de->nke', o, wo)
    r = _layernorm(o, axis=-1)
    alpha = _softmax(torch.einsum('nkd,d->nk', r, w_r), axis=-1)
    return torch.einsum('nk,nkd->nd', alpha, o)
```

```asm
; @launch grid=(256,1,1) block=(512,1,1) lds=152320
.amdgcn_target "amdgcn-amd-amdhsa--gfx950"
.text
.globl gather_scatter__hybrid_graph_tf_nagphormer__graph_kernel
.p2align 8
.type gather_scatter__hybrid_graph_tf_nagphormer__graph_kernel,@function
gather_scatter__hybrid_graph_tf_nagphormer__graph_kernel:
    s_cmp_ge_u32 s2, 256
    s_cbranch_scc1 K_END
    s_sub_u32 s3, 255, s2
    s_load_dwordx16 s[64:79], s[0:1], 0
    s_load_dwordx8 s[80:87], s[0:1], 64
    v_lshrrev_b32 v3, 6, v0
    v_and_b32 v1, 63, v0
    v_readfirstlane_b32 s36, v3
    v_lshlrev_b32 v2, 4, v1
    s_and_b32 s50, s2, 7
    s_lshr_b32 s49, s2, 3
    s_and_b32 s38, s49, 7
    s_lshr_b32 s49, s49, 3
    s_lshl_b32 s37, s50, 2
    s_add_u32 s37, s37, s49
    s_lshl_b32 s59, s50, 5
    s_lshr_b32 s52, s2, 3
    s_add_u32 s59, s59, s52
    s_lshl_b32 s59, s59, 6
    s_getreg_b32 s48, hwreg(HW_REG_XCC_ID, 0, 4)
    s_mov_b32 s40, 0
    s_movk_i32 s56, 480
    s_mul_i32 s57, s37, 81920
    s_add_u32 s57, s57, 4194304
    s_mul_i32 s53, s36, 10240
    s_lshl_b32 s54, s37, 3
    s_add_u32 s55, s54, s36
    s_add_u32 s54, s54, s38
    s_lshl_b32 s54, s54, 6
    s_lshl_b32 s55, s55, 6
    s_waitcnt lgkmcnt(0)
    s_load_dword s92, s[86:87], 0
    s_mov_b64 s[4:5], s[86:87]
    s_mov_b32 s8, s86
    s_mov_b32 s9, s87
    s_mov_b32 s10, 0x003cd300
    s_mov_b32 s11, 0x20000
    s_mov_b32 s24, s64
    s_mov_b32 s25, s65
    s_mov_b32 s26, 0x00271000
    s_mov_b32 s27, 0x20000
    s_mov_b32 s28, s70
    s_mov_b32 s29, s71
    s_mov_b32 s30, 0x00004e20
    s_mov_b32 s31, 0x20000
    s_cmp_ge_u32 s3, 254
    s_cbranch_scc1 KA_W
    s_cmp_ge_u32 s3, 160
    s_cbranch_scc1 KA_P
    s_waitcnt lgkmcnt(0)
    s_mul_i32 s46, s92, 0x9e3779b1
    s_add_u32 s46, s46, 0x85ebca6b
    s_mul_i32 s47, s46, 0x2c1b3c6d
    s_xor_b32 s47, s47, 0x297a2d39
    s_mov_b32 s92, s46
    s_and_b32 s46, s46, 0xffffff00
    s_add_u32 s60, s59, 39936
    s_cmp_lg_u32 s36, 7
    s_cbranch_scc1 K_XP1
    s_add_u32 s52, s46, s48
    v_mov_b32 v4, s52
    v_mov_b32 v5, s47
    v_mov_b32 v3, 0
    s_mov_b64 exec, 1
    buffer_store_dwordx2 v[4:5], v3, s[8:11], s60 offen sc1
    s_mov_b64 exec, -1
K_XP1:
    s_lshr_b32 s49, s3, 5
    s_and_b32 s50, s3, 31
    s_lshl_b32 s50, s50, 10
    s_cmp_lt_u32 s3, 128
    s_cbranch_scc0 KA_NW
    s_cmp_lg_u32 s36, 2
    s_cbranch_scc1 KA_NW
    s_cmp_eq_u32 s49, 1
    s_cmov_b64 s[72:73], s[74:75]
    s_cmp_eq_u32 s49, 2
    s_cmov_b64 s[72:73], s[76:77]
    s_cmp_eq_u32 s49, 3
    s_cmov_b64 s[72:73], s[78:79]
    s_mov_b32 s32, s72
    s_mov_b32 s33, s73
    s_mov_b32 s34, 0x00008000
    s_mov_b32 s35, 0x20000
    buffer_load_dwordx4 v[120:123], v2, s[32:35], s50 offen
KA_NW:
    s_mul_i32 s52, s38, 1280
    v_add_u32 v3, s52, v0
    v_lshlrev_b32 v14, 3, v3
    v_lshrrev_b32 v15, 3, v3
    v_lshlrev_b32 v15, 11, v15
    v_and_b32 v4, 7, v3
    v_lshl_add_u32 v15, v4, 3, v15
    s_lshl_b32 s52, s37, 6
    v_add_u32 v15, s52, v15
    v_bfe_u32 v3, v1, 3, 1
    v_bfe_u32 v4, v1, 4, 1
    v_bfe_u32 v5, v1, 2, 1
    v_mov_b32 v6, 0x3f80
    v_cmp_eq_u32 vcc, v3, v4
    s_nop 1
    v_cndmask_b32 v6, 0, v6, vcc
    v_cmp_eq_u32 vcc, 0, v5
    s_nop 1
    v_cndmask_b32 v16, 0, v6, vcc
    v_cndmask_b32 v18, v6, 0, vcc
    v_mov_b32 v17, v16
    v_mov_b32 v19, v18
    v_and_b32 v3, 3, v1
    v_add_u32 v4, 1, v3
    v_and_b32 v4, 3, v4
    v_lshl_or_b32 v3, v4, 2, v3
    v_mul_u32_u24 v63, 0x1111, v3
    v_lshlrev_b32 v62, 6, v1
    v_mov_b32 v3, 97408
    v_mov_b32 v4, 0
    ds_write_b32 v3, v4
    v_lshlrev_b32 v3, 4, v0
    v_add_u32 v3, 131072, v3
    v_mov_b32 v40, -1
    v_mov_b32 v41, -1
    v_mov_b32 v42, -1
    v_mov_b32 v43, -1
    ds_write_b128 v3, v[40:43]
    ds_write_b128 v3, v[40:43] offset:8192
    v_lshlrev_b32 v3, 2, v0
    v_add_u32 v3, 151552, v3
    v_mov_b32 v4, 0xf0000000
    v_cmp_gt_u32 vcc, 64, v0
    s_nop 1
    v_cndmask_b32 v4, 0, v4, vcc
    ds_write_b32 v3, v4
    s_waitcnt lgkmcnt(0)
    s_barrier
    s_branch KA_M
KA_W:
    s_cmp_eq_u32 s3, 255
    s_cmov_b32 s72, s76
    s_cmov_b32 s73, s77
    s_cmov_b32 s74, s78
    s_cmov_b32 s75, s79
    s_mov_b32 s32, s72
    s_mov_b32 s33, s73
    s_mov_b32 s34, 0x00008000
    s_mov_b32 s35, 0x20000
    s_mov_b32 s16, s74
    s_mov_b32 s17, s75
    s_mov_b32 s18, 0x00008000
    s_mov_b32 s19, 0x20000
    s_mov_b32 s68, s80
    s_mov_b32 s69, s81
    s_mov_b32 s70, 0x00000100
    s_mov_b32 s71, 0x20000
    s_lshl_b32 s49, s36, 12
    buffer_load_dwordx4 v[64:67], v2, s[32:35], s49 offen offset:0
    buffer_load_dwordx4 v[68:71], v2, s[32:35], s49 offen offset:1024
    buffer_load_dwordx4 v[72:75], v2, s[32:35], s49 offen offset:2048
    buffer_load_dwordx4 v[76:79], v2, s[32:35], s49 offen offset:3072
    buffer_load_dwordx4 v[80:83], v2, s[16:19], s49 offen offset:0
    buffer_load_dwordx4 v[84:87], v2, s[16:19], s49 offen offset:1024
    buffer_load_dwordx4 v[88:91], v2, s[16:19], s49 offen offset:2048
    buffer_load_dwordx4 v[92:95], v2, s[16:19], s49 offen offset:3072
    v_lshlrev_b32 v3, 2, v1
    buffer_load_dword v26, v3, s[68:71], 0 offen
    s_waitcnt lgkmcnt(0)
    s_mul_i32 s46, s92, 0x9e3779b1
    s_add_u32 s46, s46, 0x85ebca6b
    s_mul_i32 s47, s46, 0x2c1b3c6d
    s_xor_b32 s47, s47, 0x297a2d39
    s_mov_b32 s92, s46
    s_and_b32 s46, s46, 0xffffff00
    s_add_u32 s60, s59, 39936
    s_cmp_lg_u32 s36, 7
    s_cbranch_scc1 K_XP2
    s_add_u32 s52, s46, s48
    v_mov_b32 v4, s52
    v_mov_b32 v5, s47
    v_mov_b32 v3, 0
    s_mov_b64 exec, 1
    buffer_store_dwordx2 v[4:5], v3, s[8:11], s60 offen sc1
    s_mov_b64 exec, -1
K_XP2:
    s_mul_i32 s52, s38, 1280
    v_add_u32 v3, s52, v0
    v_lshlrev_b32 v14, 3, v3
    v_lshrrev_b32 v15, 3, v3
    v_lshlrev_b32 v15, 11, v15
    v_and_b32 v4, 7, v3
    v_lshl_add_u32 v15, v4, 3, v15
    s_lshl_b32 s52, s37, 6
    v_add_u32 v15, s52, v15
    v_bfe_u32 v3, v1, 3, 1
    v_bfe_u32 v4, v1, 4, 1
    v_bfe_u32 v5, v1, 2, 1
    v_mov_b32 v6, 0x3f80
    v_cmp_eq_u32 vcc, v3, v4
    s_nop 1
    v_cndmask_b32 v6, 0, v6, vcc
    v_cmp_eq_u32 vcc, 0, v5
    s_nop 1
    v_cndmask_b32 v16, 0, v6, vcc
    v_cndmask_b32 v18, v6, 0, vcc
    v_mov_b32 v17, v16
    v_mov_b32 v19, v18
    v_and_b32 v3, 3, v1
    v_add_u32 v4, 1, v3
    v_and_b32 v4, 3, v4
    v_lshl_or_b32 v3, v4, 2, v3
    v_mul_u32_u24 v63, 0x1111, v3
    v_lshlrev_b32 v62, 6, v1
    v_mov_b32 v3, 97408
    v_mov_b32 v4, 0
    ds_write_b32 v3, v4
    v_lshlrev_b32 v3, 4, v0
    v_add_u32 v3, 131072, v3
    v_mov_b32 v40, -1
    v_mov_b32 v41, -1
    v_mov_b32 v42, -1
    v_mov_b32 v43, -1
    ds_write_b128 v3, v[40:43]
    ds_write_b128 v3, v[40:43] offset:8192
    v_lshlrev_b32 v3, 2, v0
    v_add_u32 v3, 151552, v3
    v_mov_b32 v4, 0xf0000000
    v_cmp_gt_u32 vcc, 64, v0
    s_nop 1
    v_cndmask_b32 v4, 0, v4, vcc
    ds_write_b32 v3, v4
    v_and_b32 v20, 15, v1
    v_lshrrev_b32 v21, 4, v1
    v_lshlrev_b32 v3, 2, v0
    v_add_u32 v3, 65536, v3
    v_mov_b32 v4, 0
    v_mov_b32 v5, 0x3c000000
    ds_write_b32 v3, v4
    ds_write_b32 v3, v5 offset:2048
    v_lshl_add_u32 v7, v21, 8, s49
    v_lshlrev_b32 v6, 1, v21
    s_cmp_eq_u32 s3, 255
    s_cselect_b64 s[76:77], -1, 0
    v_add_u32 v3, 0, v21
    v_add_u32 v4, 0, v6
    v_cndmask_b32 v4, v3, v4, s[76:77]
    v_xor_b32 v3, v3, v20
    v_xor_b32 v4, v4, v20
    v_lshl_add_u32 v22, v3, 4, v7
    v_lshl_add_u32 v28, v4, 4, v7
    v_add_u32 v3, 4, v21
    v_add_u32 v4, 0, v6
    v_cndmask_b32 v4, v3, v4, s[76:77]
    v_xor_b32 v3, v3, v20
    v_xor_b32 v4, v4, v20
    v_lshl_add_u32 v23, v3, 4, v7
    v_lshl_add_u32 v29, v4, 4, v7
    v_add_u32 v3, 8, v21
    v_add_u32 v4, 8, v6
    v_cndmask_b32 v4, v3, v4, s[76:77]
    v_xor_b32 v3, v3, v20
    v_xor_b32 v4, v4, v20
    v_lshl_add_u32 v24, v3, 4, v7
    v_lshl_add_u32 v30, v4, 4, v7
    v_add_u32 v3, 12, v21
    v_add_u32 v4, 8, v6
    v_cndmask_b32 v4, v3, v4, s[76:77]
    v_xor_b32 v3, v3, v20
    v_xor_b32 v4, v4, v20
    v_lshl_add_u32 v25, v3, 4, v7
    v_lshl_add_u32 v31, v4, 4, v7
    v_lshrrev_b32 v3, 1, v21
    v_lshlrev_b32 v27, 8, v3
    v_and_b32 v3, 1, v21
    v_lshl_add_u32 v27, v3, 3, v27
    s_lshl_b32 s50, s36, 9
    v_add_u32 v27, s50, v27
    v_lshlrev_b32 v112, 2, v20
    v_add_u32 v112, 65536, v112
    v_lshlrev_b32 v113, 3, v1
    v_add_u32 v113, 65536, v113
    s_mov_b32 s72, 0x3c000000
    s_mov_b32 s73, 0x3e0293ee
    s_waitcnt vmcnt(8)
    ds_write_b128 v22, v[64:67] offset:0
    s_waitcnt vmcnt(7)
    ds_write_b128 v23, v[68:71] offset:1024
    s_waitcnt vmcnt(6)
    ds_write_b128 v24, v[72:75] offset:2048
    s_waitcnt vmcnt(5)
    ds_write_b128 v25, v[76:79] offset:3072
    s_waitcnt vmcnt(4)
    ds_write_b128 v28, v[80:83] offset:32768
    s_waitcnt vmcnt(3)
    ds_write_b128 v29, v[84:87] offset:33792
    s_waitcnt vmcnt(2)
    ds_write_b128 v30, v[88:91] offset:34816
    s_waitcnt vmcnt(1)
    ds_write_b128 v31, v[92:95] offset:35840
    v_xor_b32 v3, v21, v20
    v_lshlrev_b32 v3, 4, v3
    v_lshl_add_u32 v22, v20, 8, v3
    v_xor_b32 v23, 64, v22
    v_xor_b32 v24, 128, v22
    v_xor_b32 v25, 192, v22
    s_waitcnt vmcnt(0)
    v_lshlrev_b32 v6, 16, v26
    v_and_b32 v7, 0xffff0000, v26
    v_add_f32 v26, v6, v7
    s_nop 1
    v_add_f32_dpp v26, v26, v26 quad_perm:[1,0,3,2] row_mask:0xf bank_mask:0xf
    s_nop 1
    v_add_f32_dpp v26, v26, v26 quad_perm:[2,3,0,1] row_mask:0xf bank_mask:0xf
    s_nop 1
    v_add_f32_dpp v26, v26, v26 row_half_mirror row_mask:0xf bank_mask:0xf
    s_nop 1
    v_add_f32_dpp v26, v26, v26 row_mirror row_mask:0xf bank_mask:0xf
    v_mov_b32 v3, v26
    s_nop 1
    v_permlane16_swap_b32 v26, v3
    v_add_f32 v26, v26, v3
    v_mov_b32 v3, v26
    s_nop 1
    v_permlane32_swap_b32 v26, v3
    v_add_f32 v26, v26, v3
    v_fma_f32 v6, -v26, s72, v6
    v_fma_f32 v7, -v26, s72, v7
    s_waitcnt lgkmcnt(0)
    s_barrier
    ds_write_b64 v113, v[6:7] offset:1536
    v_cvt_pk_bf16_f32 v3, v6, v7
    v_lshlrev_b32 v4, 16, v3
    v_and_b32 v5, 0xffff0000, v3
    v_sub_f32 v6, v6, v4
    v_sub_f32 v7, v7, v5
    ds_write_b64 v113, v[6:7] offset:0
    v_add_u32 v3, s49, v22
    ds_read_b128 v[64:67], v3
    v_add_u32 v3, s49, v23
    ds_read_b128 v[68:71], v3
    v_add_u32 v3, s49, v24
    ds_read_b128 v[72:75], v3
    v_add_u32 v3, s49, v25
    ds_read_b128 v[76:79], v3
    s_cmp_eq_u32 s3, 255
    s_cbranch_scc1 KW_TR
    ds_read_b128 v[128:131], v22 offset:32768
    ds_read_b128 v[132:135], v23 offset:32768
    ds_read_b128 v[136:139], v24 offset:32768
    ds_read_b128 v[140:143], v25 offset:32768
    ds_read_b128 v[144:147], v22 offset:36864
    ds_read_b128 v[148:151], v23 offset:36864
    ds_read_b128 v[152:155], v24 offset:36864
    ds_read_b128 v[156:159], v25 offset:36864
    ds_read_b128 v[160:163], v22 offset:40960
    ds_read_b128 v[164:167], v23 offset:40960
    ds_read_b128 v[168:171], v24 offset:40960
    ds_read_b128 v[172:175], v25 offset:40960
    ds_read_b128 v[176:179], v22 offset:45056
    ds_read_b128 v[180:183], v23 offset:45056
    ds_read_b128 v[184:187], v24 offset:45056
    ds_read_b128 v[188:191], v25 offset:45056
    ds_read_b128 v[192:195], v22 offset:49152
    ds_read_b128 v[196:199], v23 offset:49152
    ds_read_b128 v[200:203], v24 offset:49152
    ds_read_b128 v[204:207], v25 offset:49152
    ds_read_b128 v[208:211], v22 offset:53248
    ds_read_b128 v[212:215], v23 offset:53248
    ds_read_b128 v[216:219], v24 offset:53248
    ds_read_b128 v[220:223], v25 offset:53248
    ds_read_b128 v[224:227], v22 offset:57344
    ds_read_b128 v[228:231], v23 offset:57344
    ds_read_b128 v[232:235], v24 offset:57344
    ds_read_b128 v[236:239], v25 offset:57344
    ds_read_b128 v[240:243], v22 offset:61440
    ds_read_b128 v[244:247], v23 offset:61440
    ds_read_b128 v[248:251], v24 offset:61440
    ds_read_b128 v[252:255], v25 offset:61440
    s_branch KW_MM
KW_TR:
    v_lshrrev_b32 v3, 2, v20
    v_and_b32 v4, 1, v21
    v_lshlrev_b32 v4, 3, v4
    v_lshl_add_u32 v4, v3, 1, v4
    v_bfe_u32 v5, v20, 1, 1
    v_xor_b32 v4, v4, v5
    v_lshlrev_b32 v4, 4, v4
    v_lshl_add_u32 v3, v21, 3, v3
    v_lshl_add_u32 v4, v3, 8, v4
    v_and_b32 v5, 1, v20
    v_lshl_add_u32 v22, v5, 3, v4
    v_xor_b32 v28, 0, v22
    ds_read_b64_tr_b16 v[128:129], v28 offset:32768
    ds_read_b64_tr_b16 v[132:133], v28 offset:40960
    ds_read_b64_tr_b16 v[136:137], v28 offset:49152
    ds_read_b64_tr_b16 v[140:141], v28 offset:57344
    ds_read_b64_tr_b16 v[130:131], v28 offset:33792
    ds_read_b64_tr_b16 v[134:135], v28 offset:41984
    ds_read_b64_tr_b16 v[138:139], v28 offset:50176
    ds_read_b64_tr_b16 v[142:143], v28 offset:58368
    v_xor_b32 v29, 32, v22
    ds_read_b64_tr_b16 v[144:145], v29 offset:32768
    ds_read_b64_tr_b16 v[148:149], v29 offset:40960
    ds_read_b64_tr_b16 v[152:153], v29 offset:49152
    ds_read_b64_tr_b16 v[156:157], v29 offset:57344
    ds_read_b64_tr_b16 v[146:147], v29 offset:33792
    ds_read_b64_tr_b16 v[150:151], v29 offset:41984
    ds_read_b64_tr_b16 v[154:155], v29 offset:50176
    ds_read_b64_tr_b16 v[158:159], v29 offset:58368
    v_xor_b32 v28, 64, v22
    ds_read_b64_tr_b16 v[160:161], v28 offset:32768
    ds_read_b64_tr_b16 v[164:165], v28 offset:40960
    ds_read_b64_tr_b16 v[168:169], v28 offset:49152
    ds_read_b64_tr_b16 v[172:173], v28 offset:57344
    ds_read_b64_tr_b16 v[162:163], v28 offset:33792
    ds_read_b64_tr_b16 v[166:167], v28 offset:41984
    ds_read_b64_tr_b16 v[170:171], v28 offset:50176
    ds_read_b64_tr_b16 v[174:175], v28 offset:58368
    v_xor_b32 v29, 96, v22
    ds_read_b64_tr_b16 v[176:177], v29 offset:32768
    ds_read_b64_tr_b16 v[180:181], v29 offset:40960
    ds_read_b64_tr_b16 v[184:185], v29 offset:49152
    ds_read_b64_tr_b16 v[188:189], v29 offset:57344
    ds_read_b64_tr_b16 v[178:179], v29 offset:33792
    ds_read_b64_tr_b16 v[182:183], v29 offset:41984
    ds_read_b64_tr_b16 v[186:187], v29 offset:50176
    ds_read_b64_tr_b16 v[190:191], v29 offset:58368
    v_xor_b32 v28, 128, v22
    ds_read_b64_tr_b16 v[192:193], v28 offset:32768
    ds_read_b64_tr_b16 v[196:197], v28 offset:40960
    ds_read_b64_tr_b16 v[200:201], v28 offset:49152
    ds_read_b64_tr_b16 v[204:205], v28 offset:57344
    ds_read_b64_tr_b16 v[194:195], v28 offset:33792
    ds_read_b64_tr_b16 v[198:199], v28 offset:41984
    ds_read_b64_tr_b16 v[202:203], v28 offset:50176
    ds_read_b64_tr_b16 v[206:207], v28 offset:58368
    v_xor_b32 v29, 160, v22
    ds_read_b64_tr_b16 v[208:209], v29 offset:32768
    ds_read_b64_tr_b16 v[212:213], v29 offset:40960
    ds_read_b64_tr_b16 v[216:217], v29 offset:49152
    ds_read_b64_tr_b16 v[220:221], v29 offset:57344
    ds_read_b64_tr_b16 v[210:211], v29 offset:33792
    ds_read_b64_tr_b16 v[214:215], v29 offset:41984
    ds_read_b64_tr_b16 v[218:219], v29 offset:50176
    ds_read_b64_tr_b16 v[222:223], v29 offset:58368
    v_xor_b32 v28, 192, v22
    ds_read_b64_tr_b16 v[224:225], v28 offset:32768
    ds_read_b64_tr_b16 v[228:229], v28 offset:40960
    ds_read_b64_tr_b16 v[232:233], v28 offset:49152
    ds_read_b64_tr_b16 v[236:237], v28 offset:57344
    ds_read_b64_tr_b16 v[226:227], v28 offset:33792
    ds_read_b64_tr_b16 v[230:231], v28 offset:41984
    ds_read_b64_tr_b16 v[234:235], v28 offset:50176
    ds_read_b64_tr_b16 v[238:239], v28 offset:58368
    v_xor_b32 v29, 224, v22
    ds_read_b64_tr_b16 v[240:241], v29 offset:32768
    ds_read_b64_tr_b16 v[244:245], v29 offset:40960
    ds_read_b64_tr_b16 v[248:249], v29 offset:49152
    ds_read_b64_tr_b16 v[252:253], v29 offset:57344
    ds_read_b64_tr_b16 v[242:243], v29 offset:33792
    ds_read_b64_tr_b16 v[246:247], v29 offset:41984
    ds_read_b64_tr_b16 v[250:251], v29 offset:50176
    ds_read_b64_tr_b16 v[254:255], v29 offset:58368
KW_MM:
    s_waitcnt lgkmcnt(0)
    v_mfma_f32_16x16x32_bf16 v[80:83], v[64:67], v[128:131], 0
    v_mfma_f32_16x16x32_bf16 v[80:83], v[68:71], v[132:135], v[80:83]
    v_mfma_f32_16x16x32_bf16 v[80:83], v[72:75], v[136:139], v[80:83]
    v_mfma_f32_16x16x32_bf16 v[80:83], v[76:79], v[140:143], v[80:83]
    v_mfma_f32_16x16x32_bf16 v[84:87], v[64:67], v[144:147], 0
    v_mfma_f32_16x16x32_bf16 v[84:87], v[68:71], v[148:151], v[84:87]
    v_mfma_f32_16x16x32_bf16 v[84:87], v[72:75], v[152:155], v[84:87]
    v_mfma_f32_16x16x32_bf16 v[84:87], v[76:79], v[156:159], v[84:87]
    v_mfma_f32_16x16x32_bf16 v[88:91], v[64:67], v[160:163], 0
    v_mfma_f32_16x16x32_bf16 v[88:91], v[68:71], v[164:167], v[88:91]
    v_mfma_f32_16x16x32_bf16 v[88:91], v[72:75], v[168:171], v[88:91]
    v_mfma_f32_16x16x32_bf16 v[88:91], v[76:79], v[172:175], v[88:91]
    v_mfma_f32_16x16x32_bf16 v[92:95], v[64:67], v[176:179], 0
    v_mfma_f32_16x16x32_bf16 v[92:95], v[68:71], v[180:183], v[92:95]
    v_mfma_f32_16x16x32_bf16 v[92:95], v[72:75], v[184:187], v[92:95]
    v_mfma_f32_16x16x32_bf16 v[92:95], v[76:79], v[188:191], v[92:95]
    v_mfma_f32_16x16x32_bf16 v[96:99], v[64:67], v[192:195], 0
    v_mfma_f32_16x16x32_bf16 v[96:99], v[68:71], v[196:199], v[96:99]
    v_mfma_f32_16x16x32_bf16 v[96:99], v[72:75], v[200:203], v[96:99]
    v_mfma_f32_16x16x32_bf16 v[96:99], v[76:79], v[204:207], v[96:99]
    v_mfma_f32_16x16x32_bf16 v[100:103], v[64:67], v[208:211], 0
    v_mfma_f32_16x16x32_bf16 v[100:103], v[68:71], v[212:215], v[100:103]
    v_mfma_f32_16x16x32_bf16 v[100:103], v[72:75], v[216:219], v[100:103]
    v_mfma_f32_16x16x32_bf16 v[100:103], v[76:79], v[220:223], v[100:103]
    v_mfma_f32_16x16x32_bf16 v[104:107], v[64:67], v[224:227], 0
    v_mfma_f32_16x16x32_bf16 v[104:107], v[68:71], v[228:231], v[104:107]
    v_mfma_f32_16x16x32_bf16 v[104:107], v[72:75], v[232:235], v[104:107]
    v_mfma_f32_16x16x32_bf16 v[104:107], v[76:79], v[236:239], v[104:107]
    v_mfma_f32_16x16x32_bf16 v[108:111], v[64:67], v[240:243], 0
    v_mfma_f32_16x16x32_bf16 v[108:111], v[68:71], v[244:247], v[108:111]
    v_mfma_f32_16x16x32_bf16 v[108:111], v[72:75], v[248:251], v[108:111]
    v_mfma_f32_16x16x32_bf16 v[108:111], v[76:79], v[252:255], v[108:111]
    v_add_f32 v3, v80, v81
    v_add_f32 v4, v82, v83
    v_add_f32 v116, v3, v4
    v_add_f32 v3, v84, v85
    v_add_f32 v4, v86, v87
    v_add_f32 v117, v3, v4
    v_add_f32 v3, v88, v89
    v_add_f32 v4, v90, v91
    v_add_f32 v118, v3, v4
    v_add_f32 v3, v92, v93
    v_add_f32 v4, v94, v95
    v_add_f32 v119, v3, v4
    v_add_f32 v3, v96, v97
    v_add_f32 v4, v98, v99
    v_add_f32 v120, v3, v4
    v_add_f32 v3, v100, v101
    v_add_f32 v4, v102, v103
    v_add_f32 v121, v3, v4
    v_add_f32 v3, v104, v105
    v_add_f32 v4, v106, v107
    v_add_f32 v122, v3, v4
    v_add_f32 v3, v108, v109
    v_add_f32 v4, v110, v111
    v_add_f32 v123, v3, v4
    v_permlane32_swap_b32 v116, v120
    v_permlane32_swap_b32 v117, v121
    v_permlane32_swap_b32 v118, v122
    v_permlane32_swap_b32 v119, v123
    v_add_f32 v116, v116, v120
    v_add_f32 v117, v117, v121
    v_add_f32 v118, v118, v122
    v_add_f32 v119, v119, v123
    s_nop 0
    v_permlane16_swap_b32 v116, v118
    v_permlane16_swap_b32 v117, v119
    v_add_f32 v116, v116, v118
    v_add_f32 v117, v117, v119
    v_lshlrev_b32 v3, 5, v20
    v_lshl_add_u32 v3, v21, 10, v3
    s_lshl_b32 s50, s36, 2
    s_add_u32 s50, s50, 69632
    v_add_u32 v3, s50, v3
    ds_write_b32 v3, v116 offset:0
    ds_write_b32 v3, v117 offset:512
    s_cmp_eq_u32 s3, 255
    s_cbranch_scc1 KW_W2
    v_add_f32 v64, v80, v84
    v_add_f32 v64, v64, v88
    v_add_f32 v64, v64, v92
    v_add_f32 v64, v64, v96
    v_add_f32 v64, v64, v100
    v_add_f32 v64, v64, v104
    v_add_f32 v64, v64, v108
    v_add_f32 v65, v81, v85
    v_add_f32 v65, v65, v89
    v_add_f32 v65, v65, v93
    v_add_f32 v65, v65, v97
    v_add_f32 v65, v65, v101
    v_add_f32 v65, v65, v105
    v_add_f32 v65, v65, v109
    v_add_f32 v66, v82, v86
    v_add_f32 v66, v66, v90
    v_add_f32 v66, v66, v94
    v_add_f32 v66, v66, v98
    v_add_f32 v66, v66, v102
    v_add_f32 v66, v66, v106
    v_add_f32 v66, v66, v110
    v_add_f32 v67, v83, v87
    v_add_f32 v67, v67, v91
    v_add_f32 v67, v67, v95
    v_add_f32 v67, v67, v99
    v_add_f32 v67, v67, v103
    v_add_f32 v67, v67, v107
    v_add_f32 v67, v67, v111
    v_add_f32_dpp v64, v64, v64 quad_perm:[1,0,3,2] row_mask:0xf bank_mask:0xf
    v_add_f32_dpp v65, v65, v65 quad_perm:[1,0,3,2] row_mask:0xf bank_mask:0xf
    v_add_f32_dpp v66, v66, v66 quad_perm:[1,0,3,2] row_mask:0xf bank_mask:0xf
    v_add_f32_dpp v67, v67, v67 quad_perm:[1,0,3,2] row_mask:0xf bank_mask:0xf
    v_add_f32_dpp v64, v64, v64 quad_perm:[2,3,0,1] row_mask:0xf bank_mask:0xf
    v_add_f32_dpp v65, v65, v65 quad_perm:[2,3,0,1] row_mask:0xf bank_mask:0xf
    v_add_f32_dpp v66, v66, v66 quad_perm:[2,3,0,1] row_mask:0xf bank_mask:0xf
    v_add_f32_dpp v67, v67, v67 quad_perm:[2,3,0,1] row_mask:0xf bank_mask:0xf
    v_add_f32_dpp v64, v64, v64 row_half_mirror row_mask:0xf bank_mask:0xf
    v_add_f32_dpp v65, v65, v65 row_half_mirror row_mask:0xf bank_mask:0xf
    v_add_f32_dpp v66, v66, v66 row_half_mirror row_mask:0xf bank_mask:0xf
    v_add_f32_dpp v67, v67, v67 row_half_mirror row_mask:0xf bank_mask:0xf
    v_add_f32_dpp v64, v64, v64 row_mirror row_mask:0xf bank_mask:0xf
    v_add_f32_dpp v65, v65, v65 row_mirror row_mask:0xf bank_mask:0xf
    v_add_f32_dpp v66, v66, v66 row_mirror row_mask:0xf bank_mask:0xf
    v_add_f32_dpp v67, v67, v67 row_mirror row_mask:0xf bank_mask:0xf
    s_waitcnt lgkmcnt(0)
    s_barrier
    v_lshlrev_b32 v3, 5, v20
    v_add_u32 v3, 69632, v3
    ds_read_b128 v[192:195], v3 offset:0
    ds_read_b128 v[196:199], v3 offset:16
    ds_read_b128 v[200:203], v3 offset:512
    ds_read_b128 v[204:207], v3 offset:528
    ds_read_b128 v[208:211], v3 offset:1024
    ds_read_b128 v[212:215], v3 offset:1040
    ds_read_b128 v[216:219], v3 offset:1536
    ds_read_b128 v[220:223], v3 offset:1552
    ds_read_b128 v[224:227], v3 offset:2048
    ds_read_b128 v[228:231], v3 offset:2064
    ds_read_b128 v[232:235], v3 offset:2560
    ds_read_b128 v[236:239], v3 offset:2576
    ds_read_b128 v[240:243], v3 offset:3072
    ds_read_b128 v[244:247], v3 offset:3088
    ds_read_b128 v[248:251], v3 offset:3584
    ds_read_b128 v[252:255], v3 offset:3600
    s_waitcnt lgkmcnt(14)
    v_add_f32 v192, v192, v196
    v_add_f32 v193, v193, v197
    v_add_f32 v194, v194, v198
    v_add_f32 v195, v195, v199
    v_add_f32 v192, v192, v193
    v_add_f32 v194, v194, v195
    v_add_f32 v116, v192, v194
    s_waitcnt lgkmcnt(12)
    v_add_f32 v200, v200, v204
    v_add_f32 v201, v201, v205
    v_add_f32 v202, v202, v206
    v_add_f32 v203, v203, v207
    v_add_f32 v200, v200, v201
    v_add_f32 v202, v202, v203
    v_add_f32 v117, v200, v202
    s_waitcnt lgkmcnt(10)
    v_add_f32 v208, v208, v212
    v_add_f32 v209, v209, v213
    v_add_f32 v210, v210, v214
    v_add_f32 v211, v211, v215
    v_add_f32 v208, v208, v209
    v_add_f32 v210, v210, v211
    v_add_f32 v118, v208, v210
    s_waitcnt lgkmcnt(8)
    v_add_f32 v216, v216, v220
    v_add_f32 v217, v217, v221
    v_add_f32 v218, v218, v222
    v_add_f32 v219, v219, v223
    v_add_f32 v216, v216, v217
    v_add_f32 v218, v218, v219
    v_add_f32 v119, v216, v218
    s_waitcnt lgkmcnt(6)
    v_add_f32 v224, v224, v228
    v_add_f32 v225, v225, v229
    v_add_f32 v226, v226, v230
    v_add_f32 v227, v227, v231
    v_add_f32 v224, v224, v225
    v_add_f32 v226, v226, v227
    v_add_f32 v120, v224, v226
    s_waitcnt lgkmcnt(4)
    v_add_f32 v232, v232, v236
    v_add_f32 v233, v233, v237
    v_add_f32 v234, v234, v238
    v_add_f32 v235, v235, v239
    v_add_f32 v232, v232, v233
    v_add_f32 v234, v234, v235
    v_add_f32 v121, v232, v234
    s_waitcnt lgkmcnt(2)
    v_add_f32 v240, v240, v244
    v_add_f32 v241, v241, v245
    v_add_f32 v242, v242, v246
    v_add_f32 v243, v243, v247
    v_add_f32 v240, v240, v241
    v_add_f32 v242, v242, v243
    v_add_f32 v122, v240, v242
    s_waitcnt lgkmcnt(0)
    v_add_f32 v248, v248, v252
    v_add_f32 v249, v249, v253
    v_add_f32 v250, v250, v254
    v_add_f32 v251, v251, v255
    v_add_f32 v248, v248, v249
    v_add_f32 v250, v250, v251
    v_add_f32 v123, v248, v250
    v_add_f32 v6, v116, v117
    v_add_f32 v6, v6, v118
    v_add_f32 v6, v6, v119
    v_add_f32 v6, v6, v120
    v_add_f32 v6, v6, v121
    v_add_f32 v6, v6, v122
    v_add_f32 v6, v6, v123
    s_nop 1
    v_add_f32_dpp v6, v6, v6 quad_perm:[1,0,3,2] row_mask:0xf bank_mask:0xf
    s_nop 1
    v_add_f32_dpp v6, v6, v6 quad_perm:[2,3,0,1] row_mask:0xf bank_mask:0xf
    s_nop 1
    v_add_f32_dpp v6, v6, v6 row_half_mirror row_mask:0xf bank_mask:0xf
    s_nop 1
    v_add_f32_dpp v6, v6, v6 row_mirror row_mask:0xf bank_mask:0xf
    v_fma_f32 v64, -v6, s72, v64
    v_fma_f32 v65, -v6, s72, v65
    v_fma_f32 v66, -v6, s72, v66
    v_fma_f32 v67, -v6, s72, v67
    v_bfe_u32 v3, v20, 2, 1
    v_lshlrev_b32 v3, 12, v3
    v_lshrrev_b32 v4, 3, v20
    v_lshl_add_u32 v3, v4, 6, v3
    v_and_b32 v4, 3, v20
    v_lshl_add_u32 v3, v4, 4, v3
    v_add_u32 v3, v3, v27
    v_add_f32 v4, v64, v116
    v_fma_f32 v80, -v4, s72, v80
    v_mul_f32 v80, s73, v80
    v_add_f32 v4, v65, v116
    v_fma_f32 v81, -v4, s72, v81
    v_mul_f32 v81, s73, v81
    v_add_f32 v4, v66, v116
    v_fma_f32 v82, -v4, s72, v82
    v_mul_f32 v82, s73, v82
    v_add_f32 v4, v67, v116
    v_fma_f32 v83, -v4, s72, v83
    v_mul_f32 v83, s73, v83
    v_cvt_pk_bf16_f32 v128, v80, v81
    v_cvt_pk_bf16_f32 v129, v82, v83
    ds_write_b64 v3, v[128:129] offset:0
    v_add_f32 v4, v64, v117
    v_fma_f32 v84, -v4, s72, v84
    v_mul_f32 v84, s73, v84
    v_add_f32 v4, v65, v117
    v_fma_f32 v85, -v4, s72, v85
    v_mul_f32 v85, s73, v85
    v_add_f32 v4, v66, v117
    v_fma_f32 v86, -v4, s72, v86
    v_mul_f32 v86, s73, v86
    v_add_f32 v4, v67, v117
    v_fma_f32 v87, -v4, s72, v87
    v_mul_f32 v87, s73, v87
    v_cvt_pk_bf16_f32 v130, v84, v85
    v_cvt_pk_bf16_f32 v131, v86, v87
    ds_write_b64 v3, v[130:131] offset:128
    v_add_f32 v4, v64, v118
    v_fma_f32 v88, -v4, s72, v88
    v_mul_f32 v88, s73, v88
    v_add_f32 v4, v65, v118
    v_fma_f32 v89, -v4, s72, v89
    v_mul_f32 v89, s73, v89
    v_add_f32 v4, v66, v118
    v_fma_f32 v90, -v4, s72, v90
    v_mul_f32 v90, s73, v90
    v_add_f32 v4, v67, v118
    v_fma_f32 v91, -v4, s72, v91
    v_mul_f32 v91, s73, v91
    v_cvt_pk_bf16_f32 v132, v88, v89
    v_cvt_pk_bf16_f32 v133, v90, v91
    ds_write_b64 v3, v[132:133] offset:8192
    v_add_f32 v4, v64, v119
    v_fma_f32 v92, -v4, s72, v92
    v_mul_f32 v92, s73, v92
    v_add_f32 v4, v65, v119
    v_fma_f32 v93, -v4, s72, v93
    v_mul_f32 v93, s73, v93
    v_add_f32 v4, v66, v119
    v_fma_f32 v94, -v4, s72, v94
    v_mul_f32 v94, s73, v94
    v_add_f32 v4, v67, v119
    v_fma_f32 v95, -v4, s72, v95
    v_mul_f32 v95, s73, v95
    v_cvt_pk_bf16_f32 v134, v92, v93
    v_cvt_pk_bf16_f32 v135, v94, v95
    ds_write_b64 v3, v[134:135] offset:8320
    v_add_f32 v4, v64, v120
    v_fma_f32 v96, -v4, s72, v96
    v_mul_f32 v96, s73, v96
    v_add_f32 v4, v65, v120
    v_fma_f32 v97, -v4, s72, v97
    v_mul_f32 v97, s73, v97
    v_add_f32 v4, v66, v120
    v_fma_f32 v98, -v4, s72, v98
    v_mul_f32 v98, s73, v98
    v_add_f32 v4, v67, v120
    v_fma_f32 v99, -v4, s72, v99
    v_mul_f32 v99, s73, v99
    v_cvt_pk_bf16_f32 v136, v96, v97
    v_cvt_pk_bf16_f32 v137, v98, v99
    ds_write_b64 v3, v[136:137] offset:16384
    v_add_f32 v4, v64, v121
    v_fma_f32 v100, -v4, s72, v100
    v_mul_f32 v100, s73, v100
    v_add_f32 v4, v65, v121
    v_fma_f32 v101, -v4, s72, v101
    v_mul_f32 v101, s73, v101
    v_add_f32 v4, v66, v121
    v_fma_f32 v102, -v4, s72, v102
    v_mul_f32 v102, s73, v102
    v_add_f32 v4, v67, v121
    v_fma_f32 v103, -v4, s72, v103
    v_mul_f32 v103, s73, v103
    v_cvt_pk_bf16_f32 v138, v100, v101
    v_cvt_pk_bf16_f32 v139, v102, v103
    ds_write_b64 v3, v[138:139] offset:16512
    v_add_f32 v4, v64, v122
    v_fma_f32 v104, -v4, s72, v104
    v_mul_f32 v104, s73, v104
    v_add_f32 v4, v65, v122
    v_fma_f32 v105, -v4, s72, v105
    v_mul_f32 v105, s73, v105
    v_add_f32 v4, v66, v122
    v_fma_f32 v106, -v4, s72, v106
    v_mul_f32 v106, s73, v106
    v_add_f32 v4, v67, v122
    v_fma_f32 v107, -v4, s72, v107
    v_mul_f32 v107, s73, v107
    v_cvt_pk_bf16_f32 v140, v104, v105
    v_cvt_pk_bf16_f32 v141, v106, v107
    ds_write_b64 v3, v[140:141] offset:24576
    v_add_f32 v4, v64, v123
    v_fma_f32 v108, -v4, s72, v108
    v_mul_f32 v108, s73, v108
    v_add_f32 v4, v65, v123
    v_fma_f32 v109, -v4, s72, v109
    v_mul_f32 v109, s73, v109
    v_add_f32 v4, v66, v123
    v_fma_f32 v110, -v4, s72, v110
    v_mul_f32 v110, s73, v110
    v_add_f32 v4, v67, v123
    v_fma_f32 v111, -v4, s72, v111
    v_mul_f32 v111, s73, v111
    v_cvt_pk_bf16_f32 v142, v108, v109
    v_cvt_pk_bf16_f32 v143, v110, v111
    ds_write_b64 v3, v[142:143] offset:24704
    v_lshlrev_b32 v4, 16, v128
    v_and_b32 v5, 0xffff0000, v128
    v_add_f32 v4, v4, v5
    v_lshlrev_b32 v5, 16, v129
    v_and_b32 v6, 0xffff0000, v129
    v_add_f32 v5, v5, v6
    v_add_f32 v116, v4, v5
    v_lshlrev_b32 v4, 16, v130
    v_and_b32 v5, 0xffff0000, v130
    v_add_f32 v4, v4, v5
    v_lshlrev_b32 v5, 16, v131
    v_and_b32 v6, 0xffff0000, v131
    v_add_f32 v5, v5, v6
    v_add_f32 v117, v4, v5
    v_lshlrev_b32 v4, 16, v132
    v_and_b32 v5, 0xffff0000, v132
    v_add_f32 v4, v4, v5
    v_lshlrev_b32 v5, 16, v133
    v_and_b32 v6, 0xffff0000, v133
    v_add_f32 v5, v5, v6
    v_add_f32 v118, v4, v5
    v_lshlrev_b32 v4, 16, v134
    v_and_b32 v5, 0xffff0000, v134
    v_add_f32 v4, v4, v5
    v_lshlrev_b32 v5, 16, v135
    v_and_b32 v6, 0xffff0000, v135
    v_add_f32 v5, v5, v6
    v_add_f32 v119, v4, v5
    v_lshlrev_b32 v4, 16, v136
    v_and_b32 v5, 0xffff0000, v136
    v_add_f32 v4, v4, v5
    v_lshlrev_b32 v5, 16, v137
    v_and_b32 v6, 0xffff0000, v137
    v_add_f32 v5, v5, v6
    v_add_f32 v120, v4, v5
    v_lshlrev_b32 v4, 16, v138
    v_and_b32 v5, 0xffff0000, v138
    v_add_f32 v4, v4, v5
    v_lshlrev_b32 v5, 16, v139
    v_and_b32 v6, 0xffff0000, v139
    v_add_f32 v5, v5, v6
    v_add_f32 v121, v4, v5
    v_lshlrev_b32 v4, 16, v140
    v_and_b32 v5, 0xffff0000, v140
    v_add_f32 v4, v4, v5
    v_lshlrev_b32 v5, 16, v141
    v_and_b32 v6, 0xffff0000, v141
    v_add_f32 v5, v5, v6
    v_add_f32 v122, v4, v5
    v_lshlrev_b32 v4, 16, v142
    v_and_b32 v5, 0xffff0000, v142
    v_add_f32 v4, v4, v5
    v_lshlrev_b32 v5, 16, v143
    v_and_b32 v6, 0xffff0000, v143
    v_add_f32 v5, v5, v6
    v_add_f32 v123, v4, v5
    s_barrier
    v_permlane32_swap_b32 v116, v120
    v_permlane32_swap_b32 v117, v121
    v_permlane32_swap_b32 v118, v122
    v_permlane32_swap_b32 v119, v123
    v_add_f32 v116, v116, v120
    v_add_f32 v117, v117, v121
    v_add_f32 v118, v118, v122
    v_add_f32 v119, v119, v123
    s_nop 0
    v_permlane16_swap_b32 v116, v118
    v_permlane16_swap_b32 v117, v119
    v_add_f32 v116, v116, v118
    v_add_f32 v117, v117, v119
    v_lshlrev_b32 v3, 5, v20
    v_lshl_add_u32 v3, v21, 10, v3
    s_lshl_b32 s50, s36, 2
    s_add_u32 s50, s50, 69632
    v_add_u32 v3, s50, v3
    ds_write_b32 v3, v116 offset:0
    ds_write_b32 v3, v117 offset:512
    s_mov_b32 s51, 190464
    s_branch KW_OUT
KW_W2:
    s_waitcnt lgkmcnt(0)
    s_barrier
    ds_read_b32 v64, v112 offset:1536
    ds_read_b32 v65, v112 offset:1600
    ds_read_b32 v66, v112 offset:1664
    ds_read_b32 v67, v112 offset:1728
    ds_read_b32 v68, v112 offset:1792
    ds_read_b32 v69, v112 offset:1856
    ds_read_b32 v70, v112 offset:1920
    ds_read_b32 v71, v112 offset:1984
    s_waitcnt lgkmcnt(0)
    v_lshlrev_b32 v3, 5, v20
    v_add_u32 v3, 69632, v3
    ds_read_b128 v[192:195], v3 offset:0
    ds_read_b128 v[196:199], v3 offset:16
    ds_read_b128 v[200:203], v3 offset:512
    ds_read_b128 v[204:207], v3 offset:528
    ds_read_b128 v[208:211], v3 offset:1024
    ds_read_b128 v[212:215], v3 offset:1040
    ds_read_b128 v[216:219], v3 offset:1536
    ds_read_b128 v[220:223], v3 offset:1552
    ds_read_b128 v[224:227], v3 offset:2048
    ds_read_b128 v[228:231], v3 offset:2064
    ds_read_b128 v[232:235], v3 offset:2560
    ds_read_b128 v[236:239], v3 offset:2576
    ds_read_b128 v[240:243], v3 offset:3072
    ds_read_b128 v[244:247], v3 offset:3088
    ds_read_b128 v[248:251], v3 offset:3584
    ds_read_b128 v[252:255], v3 offset:3600
    s_waitcnt lgkmcnt(14)
    v_add_f32 v192, v192, v196
    v_add_f32 v193, v193, v197
    v_add_f32 v194, v194, v198
    v_add_f32 v195, v195, v199
    v_add_f32 v192, v192, v193
    v_add_f32 v194, v194, v195
    v_add_f32 v116, v192, v194
    s_waitcnt lgkmcnt(12)
    v_add_f32 v200, v200, v204
    v_add_f32 v201, v201, v205
    v_add_f32 v202, v202, v206
    v_add_f32 v203, v203, v207
    v_add_f32 v200, v200, v201
    v_add_f32 v202, v202, v203
    v_add_f32 v117, v200, v202
    s_waitcnt lgkmcnt(10)
    v_add_f32 v208, v208, v212
    v_add_f32 v209, v209, v213
    v_add_f32 v210, v210, v214
    v_add_f32 v211, v211, v215
    v_add_f32 v208, v208, v209
    v_add_f32 v210, v210, v211
    v_add_f32 v118, v208, v210
    s_waitcnt lgkmcnt(8)
    v_add_f32 v216, v216, v220
    v_add_f32 v217, v217, v221
    v_add_f32 v218, v218, v222
    v_add_f32 v219, v219, v223
    v_add_f32 v216, v216, v217
    v_add_f32 v218, v218, v219
    v_add_f32 v119, v216, v218
    s_waitcnt lgkmcnt(6)
    v_add_f32 v224, v224, v228
    v_add_f32 v225, v225, v229
    v_add_f32 v226, v226, v230
    v_add_f32 v227, v227, v231
    v_add_f32 v224, v224, v225
    v_add_f32 v226, v226, v227
    v_add_f32 v120, v224, v226
    s_waitcnt lgkmcnt(4)
    v_add_f32 v232, v232, v236
    v_add_f32 v233, v233, v237
    v_add_f32 v234, v234, v238
    v_add_f32 v235, v235, v239
    v_add_f32 v232, v232, v233
    v_add_f32 v234, v234, v235
    v_add_f32 v121, v232, v234
    s_waitcnt lgkmcnt(2)
    v_add_f32 v240, v240, v244
    v_add_f32 v241, v241, v245
    v_add_f32 v242, v242, v246
    v_add_f32 v243, v243, v247
    v_add_f32 v240, v240, v241
    v_add_f32 v242, v242, v243
    v_add_f32 v122, v240, v242
    s_waitcnt lgkmcnt(0)
    v_add_f32 v248, v248, v252
    v_add_f32 v249, v249, v253
    v_add_f32 v250, v250, v254
    v_add_f32 v251, v251, v255
    v_add_f32 v248, v248, v249
    v_add_f32 v250, v250, v251
    v_add_f32 v123, v248, v250
    v_lshlrev_b32 v3, 4, v20
    v_add_u32 v3, v3, v27
    s_waitcnt lgkmcnt(0)
    v_fma_f32 v80, -v116, s72, v80
    v_mul_f32 v160, v80, v64
    v_fma_f32 v81, -v116, s72, v81
    v_mul_f32 v161, v81, v64
    v_fma_f32 v82, -v116, s72, v82
    v_mul_f32 v162, v82, v64
    v_fma_f32 v83, -v116, s72, v83
    v_mul_f32 v163, v83, v64
    v_cvt_pk_bf16_f32 v128, v80, v81
    v_cvt_pk_bf16_f32 v129, v82, v83
    ds_write_b64 v3, v[128:129] offset:0
    v_fma_f32 v84, -v117, s72, v84
    v_mul_f32 v164, v84, v65
    v_fma_f32 v85, -v117, s72, v85
    v_mul_f32 v165, v85, v65
    v_fma_f32 v86, -v117, s72, v86
    v_mul_f32 v166, v86, v65
    v_fma_f32 v87, -v117, s72, v87
    v_mul_f32 v167, v87, v65
    v_cvt_pk_bf16_f32 v130, v84, v85
    v_cvt_pk_bf16_f32 v131, v86, v87
    ds_write_b64 v3, v[130:131] offset:4096
    v_fma_f32 v88, -v118, s72, v88
    v_mul_f32 v168, v88, v66
    v_fma_f32 v89, -v118, s72, v89
    v_mul_f32 v169, v89, v66
    v_fma_f32 v90, -v118, s72, v90
    v_mul_f32 v170, v90, v66
    v_fma_f32 v91, -v118, s72, v91
    v_mul_f32 v171, v91, v66
    v_cvt_pk_bf16_f32 v132, v88, v89
    v_cvt_pk_bf16_f32 v133, v90, v91
    ds_write_b64 v3, v[132:133] offset:8192
    v_fma_f32 v92, -v119, s72, v92
    v_mul_f32 v172, v92, v67
    v_fma_f32 v93, -v119, s72, v93
    v_mul_f32 v173, v93, v67
    v_fma_f32 v94, -v119, s72, v94
    v_mul_f32 v174, v94, v67
    v_fma_f32 v95, -v119, s72, v95
    v_mul_f32 v175, v95, v67
    v_cvt_pk_bf16_f32 v134, v92, v93
    v_cvt_pk_bf16_f32 v135, v94, v95
    ds_write_b64 v3, v[134:135] offset:12288
    v_fma_f32 v96, -v120, s72, v96
    v_mul_f32 v176, v96, v68
    v_fma_f32 v97, -v120, s72, v97
    v_mul_f32 v177, v97, v68
    v_fma_f32 v98, -v120, s72, v98
    v_mul_f32 v178, v98, v68
    v_fma_f32 v99, -v120, s72, v99
    v_mul_f32 v179, v99, v68
    v_cvt_pk_bf16_f32 v136, v96, v97
    v_cvt_pk_bf16_f32 v137, v98, v99
    ds_write_b64 v3, v[136:137] offset:16384
    v_fma_f32 v100, -v121, s72, v100
    v_mul_f32 v180, v100, v69
    v_fma_f32 v101, -v121, s72, v101
    v_mul_f32 v181, v101, v69
    v_fma_f32 v102, -v121, s72, v102
    v_mul_f32 v182, v102, v69
    v_fma_f32 v103, -v121, s72, v103
    v_mul_f32 v183, v103, v69
    v_cvt_pk_bf16_f32 v138, v100, v101
    v_cvt_pk_bf16_f32 v139, v102, v103
    ds_write_b64 v3, v[138:139] offset:20480
    v_fma_f32 v104, -v122, s72, v104
    v_mul_f32 v184, v104, v70
    v_fma_f32 v105, -v122, s72, v105
    v_mul_f32 v185, v105, v70
    v_fma_f32 v106, -v122, s72, v106
    v_mul_f32 v186, v106, v70
    v_fma_f32 v107, -v122, s72, v107
    v_mul_f32 v187, v107, v70
    v_cvt_pk_bf16_f32 v140, v104, v105
    v_cvt_pk_bf16_f32 v141, v106, v107
    ds_write_b64 v3, v[140:141] offset:24576
    v_fma_f32 v108, -v123, s72, v108
    v_mul_f32 v188, v108, v71
    v_fma_f32 v109, -v123, s72, v109
    v_mul_f32 v189, v109, v71
    v_fma_f32 v110, -v123, s72, v110
    v_mul_f32 v190, v110, v71
    v_fma_f32 v111, -v123, s72, v111
    v_mul_f32 v191, v111, v71
    v_cvt_pk_bf16_f32 v142, v108, v109
    v_cvt_pk_bf16_f32 v143, v110, v111
    ds_write_b64 v3, v[142:143] offset:28672
    v_add_f32 v72, v80, v84
    v_add_f32 v72, v72, v88
    v_add_f32 v72, v72, v92
    v_add_f32 v72, v72, v96
    v_add_f32 v72, v72, v100
    v_add_f32 v72, v72, v104
    v_add_f32 v72, v72, v108
    v_add_f32 v73, v81, v85
    v_add_f32 v73, v73, v89
    v_add_f32 v73, v73, v93
    v_add_f32 v73, v73, v97
    v_add_f32 v73, v73, v101
    v_add_f32 v73, v73, v105
    v_add_f32 v73, v73, v109
    v_add_f32 v74, v82, v86
    v_add_f32 v74, v74, v90
    v_add_f32 v74, v74, v94
    v_add_f32 v74, v74, v98
    v_add_f32 v74, v74, v102
    v_add_f32 v74, v74, v106
    v_add_f32 v74, v74, v110
    v_add_f32 v75, v83, v87
    v_add_f32 v75, v75, v91
    v_add_f32 v75, v75, v95
    v_add_f32 v75, v75, v99
    v_add_f32 v75, v75, v103
    v_add_f32 v75, v75, v107
    v_add_f32 v75, v75, v111
    v_add_f32_dpp v72, v72, v72 quad_perm:[1,0,3,2] row_mask:0xf bank_mask:0xf
    v_add_f32_dpp v73, v73, v73 quad_perm:[1,0,3,2] row_mask:0xf bank_mask:0xf
    v_add_f32_dpp v74, v74, v74 quad_perm:[1,0,3,2] row_mask:0xf bank_mask:0xf
    v_add_f32_dpp v75, v75, v75 quad_perm:[1,0,3,2] row_mask:0xf bank_mask:0xf
    v_add_f32_dpp v72, v72, v72 quad_perm:[2,3,0,1] row_mask:0xf bank_mask:0xf
    v_add_f32_dpp v73, v73, v73 quad_perm:[2,3,0,1] row_mask:0xf bank_mask:0xf
    v_add_f32_dpp v74, v74, v74 quad_perm:[2,3,0,1] row_mask:0xf bank_mask:0xf
    v_add_f32_dpp v75, v75, v75 quad_perm:[2,3,0,1] row_mask:0xf bank_mask:0xf
    v_add_f32_dpp v72, v72, v72 row_half_mirror row_mask:0xf bank_mask:0xf
    v_add_f32_dpp v73, v73, v73 row_half_mirror row_mask:0xf bank_mask:0xf
    v_add_f32_dpp v74, v74, v74 row_half_mirror row_mask:0xf bank_mask:0xf
    v_add_f32_dpp v75, v75, v75 row_half_mirror row_mask:0xf bank_mask:0xf
    v_add_f32_dpp v72, v72, v72 row_mirror row_mask:0xf bank_mask:0xf
    v_add_f32_dpp v73, v73, v73 row_mirror row_mask:0xf bank_mask:0xf
    v_add_f32_dpp v74, v74, v74 row_mirror row_mask:0xf bank_mask:0xf
    v_add_f32_dpp v75, v75, v75 row_mirror row_mask:0xf bank_mask:0xf
    v_add_f32 v76, v160, v164
    v_add_f32 v76, v76, v168
    v_add_f32 v76, v76, v172
    v_add_f32 v76, v76, v176
    v_add_f32 v76, v76, v180
    v_add_f32 v76, v76, v184
    v_add_f32 v76, v76, v188
    v_add_f32 v77, v161, v165
    v_add_f32 v77, v77, v169
    v_add_f32 v77, v77, v173
    v_add_f32 v77, v77, v177
    v_add_f32 v77, v77, v181
    v_add_f32 v77, v77, v185
    v_add_f32 v77, v77, v189
    v_add_f32 v78, v162, v166
    v_add_f32 v78, v78, v170
    v_add_f32 v78, v78, v174
    v_add_f32 v78, v78, v178
    v_add_f32 v78, v78, v182
    v_add_f32 v78, v78, v186
    v_add_f32 v78, v78, v190
    v_add_f32 v79, v163, v167
    v_add_f32 v79, v79, v171
    v_add_f32 v79, v79, v175
    v_add_f32 v79, v79, v179
    v_add_f32 v79, v79, v183
    v_add_f32 v79, v79, v187
    v_add_f32 v79, v79, v191
    v_add_f32_dpp v76, v76, v76 quad_perm:[1,0,3,2] row_mask:0xf bank_mask:0xf
    v_add_f32_dpp v77, v77, v77 quad_perm:[1,0,3,2] row_mask:0xf bank_mask:0xf
    v_add_f32_dpp v78, v78, v78 quad_perm:[1,0,3,2] row_mask:0xf bank_mask:0xf
    v_add_f32_dpp v79, v79, v79 quad_perm:[1,0,3,2] row_mask:0xf bank_mask:0xf
    v_add_f32_dpp v76, v76, v76 quad_perm:[2,3,0,1] row_mask:0xf bank_mask:0xf
    v_add_f32_dpp v77, v77, v77 quad_perm:[2,3,0,1] row_mask:0xf bank_mask:0xf
    v_add_f32_dpp v78, v78, v78 quad_perm:[2,3,0,1] row_mask:0xf bank_mask:0xf
    v_add_f32_dpp v79, v79, v79 quad_perm:[2,3,0,1] row_mask:0xf bank_mask:0xf
    v_add_f32_dpp v76, v76, v76 row_half_mirror row_mask:0xf bank_mask:0xf
    v_add_f32_dpp v77, v77, v77 row_half_mirror row_mask:0xf bank_mask:0xf
    v_add_f32_dpp v78, v78, v78 row_half_mirror row_mask:0xf bank_mask:0xf
    v_add_f32_dpp v79, v79, v79 row_half_mirror row_mask:0xf bank_mask:0xf
    v_add_f32_dpp v76, v76, v76 row_mirror row_mask:0xf bank_mask:0xf
    v_add_f32_dpp v77, v77, v77 row_mirror row_mask:0xf bank_mask:0xf
    v_add_f32_dpp v78, v78, v78 row_mirror row_mask:0xf bank_mask:0xf
    v_add_f32_dpp v79, v79, v79 row_mirror row_mask:0xf bank_mask:0xf
    v_mul_f32 v72, s72, v72
    v_mul_f32 v73, s72, v73
    v_mul_f32 v74, s72, v74
    v_mul_f32 v75, s72, v75
    v_lshlrev_b32 v3, 4, v21
    s_lshl_b32 s50, s36, 6
    s_add_u32 s50, s50, 65536
    v_add_u32 v3, s50, v3
    ds_write_b128 v3, v[72:75] offset:512
    ds_write_b128 v3, v[76:79] offset:1024
    s_mov_b32 s51, 223232
KW_OUT:
    s_waitcnt lgkmcnt(0)
    s_barrier
    v_add_u32 v3, s49, v2
    s_add_u32 s51, s51, s49
    ds_read_b128 v[64:67], v3 offset:0
    ds_read_b128 v[68:71], v3 offset:1024
    ds_read_b128 v[72:75], v3 offset:2048
    ds_read_b128 v[76:79], v3 offset:3072
    s_waitcnt lgkmcnt(3)
    buffer_store_dwordx4 v[64:67], v2, s[8:11], s51 offen offset:0 sc1
    s_waitcnt lgkmcnt(2)
    buffer_store_dwordx4 v[68:71], v2, s[8:11], s51 offen offset:1024 sc1
    s_waitcnt lgkmcnt(1)
    buffer_store_dwordx4 v[72:75], v2, s[8:11], s51 offen offset:2048 sc1
    s_waitcnt lgkmcnt(0)
    buffer_store_dwordx4 v[76:79], v2, s[8:11], s51 offen offset:3072 sc1
    s_cmp_ge_u32 s36, 4
    s_cbranch_scc1 KW_FIN
    s_mov_b32 s76, 0x02000200
    s_mov_b32 s77, 0x02000200
    s_cmp_eq_u32 s3, 255
    s_cbranch_scc1 KW_K
    v_lshlrev_b32 v3, 5, v20
    v_add_u32 v3, 69632, v3
    ds_read_b128 v[192:195], v3 offset:0
    ds_read_b128 v[196:199], v3 offset:16
    ds_read_b128 v[200:203], v3 offset:512
    ds_read_b128 v[204:207], v3 offset:528
    ds_read_b128 v[208:211], v3 offset:1024
    ds_read_b128 v[212:215], v3 offset:1040
    ds_read_b128 v[216:219], v3 offset:1536
    ds_read_b128 v[220:223], v3 offset:1552
    ds_read_b128 v[224:227], v3 offset:2048
    ds_read_b128 v[228:231], v3 offset:2064
    ds_read_b128 v[232:235], v3 offset:2560
    ds_read_b128 v[236:239], v3 offset:2576
    ds_read_b128 v[240:243], v3 offset:3072
    ds_read_b128 v[244:247], v3 offset:3088
    ds_read_b128 v[248:251], v3 offset:3584
    ds_read_b128 v[252:255], v3 offset:3600
    s_waitcnt lgkmcnt(14)
    v_add_f32 v192, v192, v196
    v_add_f32 v193, v193, v197
    v_add_f32 v194, v194, v198
    v_add_f32 v195, v195, v199
    v_add_f32 v192, v192, v193
    v_add_f32 v194, v194, v195
    v_add_f32 v116, v192, v194
    s_waitcnt lgkmcnt(12)
    v_add_f32 v200, v200, v204
    v_add_f32 v201, v201, v205
    v_add_f32 v202, v202, v206
    v_add_f32 v203, v203, v207
    v_add_f32 v200, v200, v201
    v_add_f32 v202, v202, v203
    v_add_f32 v117, v200, v202
    s_waitcnt lgkmcnt(10)
    v_add_f32 v208, v208, v212
    v_add_f32 v209, v209, v213
    v_add_f32 v210, v210, v214
    v_add_f32 v211, v211, v215
    v_add_f32 v208, v208, v209
    v_add_f32 v210, v210, v211
    v_add_f32 v118, v208, v210
    s_waitcnt lgkmcnt(8)
    v_add_f32 v216, v216, v220
    v_add_f32 v217, v217, v221
    v_add_f32 v218, v218, v222
    v_add_f32 v219, v219, v223
    v_add_f32 v216, v216, v217
    v_add_f32 v218, v218, v219
    v_add_f32 v119, v216, v218
    s_waitcnt lgkmcnt(6)
    v_add_f32 v224, v224, v228
    v_add_f32 v225, v225, v229
    v_add_f32 v226, v226, v230
    v_add_f32 v227, v227, v231
    v_add_f32 v224, v224, v225
    v_add_f32 v226, v226, v227
    v_add_f32 v120, v224, v226
    s_waitcnt lgkmcnt(4)
    v_add_f32 v232, v232, v236
    v_add_f32 v233, v233, v237
    v_add_f32 v234, v234, v238
    v_add_f32 v235, v235, v239
    v_add_f32 v232, v232, v233
    v_add_f32 v234, v234, v235
    v_add_f32 v121, v232, v234
    s_waitcnt lgkmcnt(2)
    v_add_f32 v240, v240, v244
    v_add_f32 v241, v241, v245
    v_add_f32 v242, v242, v246
    v_add_f32 v243, v243, v247
    v_add_f32 v240, v240, v241
    v_add_f32 v242, v242, v243
    v_add_f32 v122, v240, v242
    s_waitcnt lgkmcnt(0)
    v_add_f32 v248, v248, v252
    v_add_f32 v249, v249, v253
    v_add_f32 v250, v250, v254
    v_add_f32 v251, v251, v255
    v_add_f32 v248, v248, v249
    v_add_f32 v250, v250, v251
    v_add_f32 v123, v248, v250
    ds_write_b32 v112, v116 offset:0
    ds_write_b32 v112, v117 offset:64
    ds_write_b32 v112, v118 offset:128
    ds_write_b32 v112, v119 offset:192
    ds_write_b32 v112, v120 offset:256
    ds_write_b32 v112, v121 offset:320
    ds_write_b32 v112, v122 offset:384
    ds_write_b32 v112, v123 offset:448
    s_not_b64 s[76:77], s[76:77]
KW_K:
    v_and_b32 v4, 3, v20
    v_mov_b32 v3, 2048
    v_mov_b32 v5, 0
    v_mov_b32 v6, 512
    v_mov_b32 v7, 1024
    v_cmp_eq_u32 vcc, 1, v4
    s_nop 1
    v_cndmask_b32 v3, v3, v5, vcc
    v_cmp_eq_u32 vcc, 2, v4
    s_nop 1
    v_cndmask_b32 v3, v3, v6, vcc
    v_cmp_eq_u32 vcc, 3, v4
    s_nop 1
    v_cndmask_b32 v3, v3, v7, vcc
    v_mov_b32 v5, 1536
    v_cmp_eq_u32 vcc, 1, v20
    s_nop 1
    v_cndmask_b32 v3, v3, v5, vcc
    s_lshl_b32 s50, s36, 7
    s_add_u32 s50, s50, 65536
    v_lshl_add_u32 v3, v21, 5, v3
    v_add_u32 v3, s50, v3
    ds_read_b128 v[80:83], v3
    ds_read_b128 v[84:87], v3 offset:16
    s_lshl_b32 s50, s36, 10
    s_add_u32 s50, s50, 256000
    s_waitcnt lgkmcnt(0)
    v_cvt_pk_bf16_f32 v88, v80, v81
    v_cvt_pk_bf16_f32 v89, v82, v83
    v_cvt_pk_bf16_f32 v90, v84, v85
    v_cvt_pk_bf16_f32 v91, v86, v87
    s_andn2_b64 exec, -1, s[76:77]
    buffer_store_dwordx4 v[88:91], v2, s[8:11], s50 offen sc1
    s_mov_b64 exec, -1
KW_FIN:
    s_sub_u32 s49, s3, 254
    s_lshl_b32 s49, s49, 6
    s_add_u32 s49, s49, 38912
    s_waitcnt vmcnt(0)
    s_barrier
    s_cmp_lg_u32 s36, 0
    s_cbranch_scc1 KA_WP
    s_add_u32 s52, s46, 0
    v_mov_b32 v4, s52
    v_mov_b32 v5, s47
    v_mov_b32 v3, 0
    s_mov_b64 exec, 1
    buffer_store_dwordx2 v[4:5], v3, s[8:11], s49 offen sc1
    s_mov_b64 exec, -1
KA_WP:
    s_branch KA_M
KA_P:
    v_lshlrev_b32 v20, 4, v0
    s_sub_u32 s51, s3, 160
    s_mul_i32 s49, s51, 6816
    s_mov_b32 s32, s66
    s_mov_b32 s33, s67
    s_mov_b32 s34, 0x0009c400
    s_mov_b32 s35, 0x20000
    s_mov_b32 s16, s68
    s_mov_b32 s17, s69
    s_mov_b32 s18, 0x0009c400
    s_mov_b32 s19, 0x20000
    buffer_load_dwordx4 v[64:67], v20, s[16:19], s49 offen
    buffer_load_dwordx4 v[68:71], v20, s[32:35], s49 offen
    v_add_u32 v21, s49, v20
    v_cmp_gt_u32 vcc, 426, v0
    v_cmp_gt_u32 s[64:65], s34, v21
    s_nop 0
    s_and_b64 s[64:65], s[64:65], vcc
    v_mov_b32 v84, 0
    v_lshlrev_b32 v85, 2, v0
    ds_write_b32 v85, v84 offset:24576
    s_waitcnt lgkmcnt(0)
    s_mul_i32 s46, s92, 0x9e3779b1
    s_add_u32 s46, s46, 0x85ebca6b
    s_mul_i32 s47, s46, 0x2c1b3c6d
    s_xor_b32 s47, s47, 0x297a2d39
    s_mov_b32 s92, s46
    s_and_b32 s46, s46, 0xffffff00
    s_bfe_u32 s72, s47, 0x70000
    s_lshl_b32 s72, s72, 16
    s_bfe_u32 s73, s47, 0x70007
    s_lshl_b32 s73, s73, 16
    s_or_b32 s73, s73, 16384
    s_bfe_u32 s74, s47, 0x7000e
    s_lshl_b32 s74, s74, 16
    s_or_b32 s74, s74, 32768
    s_bfe_u32 s75, s47, 0x70015
    s_lshl_b32 s75, s75, 16
    s_or_b32 s75, s75, 49152
    s_or_b32 s50, s72, 0xe0000000
    v_mov_b32 v80, s50
    s_or_b32 s50, s73, 0xe0000000
    v_mov_b32 v81, s50
    s_or_b32 s50, s74, 0xe0000000
    v_mov_b32 v82, s50
    s_or_b32 s50, s75, 0xe0000000
    v_mov_b32 v83, s50
    ds_write_b128 v20, v[80:83] offset:0
    ds_write_b128 v20, v[80:83] offset:8192
    ds_write_b128 v20, v[80:83] offset:16384
    s_add_u32 s60, s59, 39936
    s_cmp_lg_u32 s36, 7
    s_cbranch_scc1 K_XP3
    s_add_u32 s52, s46, s48
    v_mov_b32 v4, s52
    v_mov_b32 v5, s47
    v_mov_b32 v3, 0
    s_mov_b64 exec, 1
    buffer_store_dwordx2 v[4:5], v3, s[8:11], s60 offen sc1
    s_mov_b64 exec, -1
K_XP3:
    s_mul_i32 s52, s38, 1280
    v_add_u32 v3, s52, v0
    v_lshlrev_b32 v14, 3, v3
    v_lshrrev_b32 v15, 3, v3
    v_lshlrev_b32 v15, 11, v15
    v_and_b32 v4, 7, v3
    v_lshl_add_u32 v15, v4, 3, v15
    s_lshl_b32 s52, s37, 6
    v_add_u32 v15, s52, v15
    v_bfe_u32 v3, v1, 3, 1
    v_bfe_u32 v4, v1, 4, 1
    v_bfe_u32 v5, v1, 2, 1
    v_mov_b32 v6, 0x3f80
    v_cmp_eq_u32 vcc, v3, v4
    s_nop 1
    v_cndmask_b32 v6, 0, v6, vcc
    v_cmp_eq_u32 vcc, 0, v5
    s_nop 1
    v_cndmask_b32 v16, 0, v6, vcc
    v_cndmask_b32 v18, v6, 0, vcc
    v_mov_b32 v17, v16
    v_mov_b32 v19, v18
    v_and_b32 v3, 3, v1
    v_add_u32 v4, 1, v3
    v_and_b32 v4, 3, v4
    v_lshl_or_b32 v3, v4, 2, v3
    v_mul_u32_u24 v63, 0x1111, v3
    v_lshlrev_b32 v62, 6, v1
    v_mov_b32 v3, 97408
    v_mov_b32 v4, 0
    ds_write_b32 v3, v4
    v_lshlrev_b32 v3, 4, v0
    v_add_u32 v3, 131072, v3
    v_mov_b32 v40, -1
    v_mov_b32 v41, -1
    v_mov_b32 v42, -1
    v_mov_b32 v43, -1
    ds_write_b128 v3, v[40:43]
    ds_write_b128 v3, v[40:43] offset:8192
    v_lshlrev_b32 v3, 2, v0
    v_add_u32 v3, 151552, v3
    v_mov_b32 v4, 0xf0000000
    v_cmp_gt_u32 vcc, 64, v0
    s_nop 1
    v_cndmask_b32 v4, 0, v4, vcc
    ds_write_b32 v3, v4
    v_mov_b32 v84, 1
    s_waitcnt lgkmcnt(0)
    s_barrier
    s_mov_b64 exec, s[64:65]
    s_waitcnt vmcnt(1)
    v_lshrrev_b32 v104, 6, v64
    v_lshlrev_b32 v96, 2, v104
    v_lshrrev_b32 v105, 6, v65
    v_lshlrev_b32 v97, 2, v105
    v_lshrrev_b32 v106, 6, v66
    v_lshlrev_b32 v98, 2, v106
    v_lshrrev_b32 v107, 6, v67
    v_lshlrev_b32 v99, 2, v107
    ds_add_rtn_u32 v88, v96, v84 offset:24576
    ds_add_rtn_u32 v89, v97, v84 offset:24576
    ds_add_rtn_u32 v90, v98, v84 offset:24576
    ds_add_rtn_u32 v91, v99, v84 offset:24576
    s_waitcnt vmcnt(0)
    s_or_b32 s49, s75, 0xc0000000
    v_mov_b32 v86, s49
    v_mov_b32 v87, s47
    v_and_b32 v85, 63, v64
    v_lshl_or_b32 v96, v85, 23, v68
    v_lshlrev_b32 v104, 7, v104
    v_and_b32 v85, 63, v65
    v_lshl_or_b32 v97, v85, 23, v69
    v_lshlrev_b32 v105, 7, v105
    v_and_b32 v85, 63, v66
    v_lshl_or_b32 v98, v85, 23, v70
    v_lshlrev_b32 v106, 7, v106
    v_and_b32 v85, 63, v67
    v_lshl_or_b32 v99, v85, 23, v71
    v_lshlrev_b32 v107, 7, v107
    s_waitcnt lgkmcnt(3)
    v_and_b32 v85, 3, v88
    v_mul_u32_u24 v83, 7, v85
    v_bfe_u32 v83, v87, v83, 7
    v_lshl_or_b32 v85, v83, 2, v85
    v_lshl_or_b32 v96, v85, 14, v96
    v_cmp_lt_u32 vcc, 30, v88
    v_min_u32 v88, 31, v88
    s_nop 0
    v_cndmask_b32 v96, v96, v86, vcc
    v_lshl_add_u32 v104, v88, 2, v104
    ds_write_b32 v104, v96
    s_waitcnt lgkmcnt(3)
    v_and_b32 v85, 3, v89
    v_mul_u32_u24 v83, 7, v85
    v_bfe_u32 v83, v87, v83, 7
    v_lshl_or_b32 v85, v83, 2, v85
    v_lshl_or_b32 v97, v85, 14, v97
    v_cmp_lt_u32 vcc, 30, v89
    v_min_u32 v89, 31, v89
    s_nop 0
    v_cndmask_b32 v97, v97, v86, vcc
    v_lshl_add_u32 v105, v89, 2, v105
    ds_write_b32 v105, v97
    s_waitcnt lgkmcnt(3)
    v_and_b32 v85, 3, v90
    v_mul_u32_u24 v83, 7, v85
    v_bfe_u32 v83, v87, v83, 7
    v_lshl_or_b32 v85, v83, 2, v85
    v_lshl_or_b32 v98, v85, 14, v98
    v_cmp_lt_u32 vcc, 30, v90
    v_min_u32 v90, 31, v90
    s_nop 0
    v_cndmask_b32 v98, v98, v86, vcc
    v_lshl_add_u32 v106, v90, 2, v106
    ds_write_b32 v106, v98
    s_waitcnt lgkmcnt(3)
    v_and_b32 v85, 3, v91
    v_mul_u32_u24 v83, 7, v85
    v_bfe_u32 v83, v87, v83, 7
    v_lshl_or_b32 v85, v83, 2, v85
    v_lshl_or_b32 v99, v85, 14, v99
    v_cmp_lt_u32 vcc, 30, v91
    v_min_u32 v91, 31, v91
    s_nop 0
    v_cndmask_b32 v99, v99, v86, vcc
    v_lshl_add_u32 v107, v91, 2, v107
    ds_write_b32 v107, v99
    s_mov_b64 exec, -1
    s_mul_i32 s49, s51, 20096
    s_add_u32 s49, s49, 2097152
    v_cmp_gt_u32 vcc, 232, v0
    s_waitcnt lgkmcnt(0)
    s_barrier
    ds_read_b128 v[64:67], v20 offset:0
    ds_read_b128 v[68:71], v20 offset:8192
    ds_read_b128 v[72:75], v20 offset:16384
    s_waitcnt lgkmcnt(2)
    buffer_store_dwordx4 v[64:67], v20, s[8:11], s49 offen sc1
    s_add_u32 s49, s49, 8192
    s_waitcnt lgkmcnt(1)
    buffer_store_dwordx4 v[68:71], v20, s[8:11], s49 offen sc1
    s_add_u32 s49, s49, 8192
    s_waitcnt lgkmcnt(0)
    s_and_saveexec_b64 s[66:67], vcc
    s_cbranch_execz KA_P4
    buffer_store_dwordx4 v[72:75], v20, s[8:11], s49 offen sc1
KA_P4:
    s_mov_b64 exec, -1
    s_barrier
    s_cmp_ge_u32 s3, 248
    s_cbranch_scc1 KA_M
    s_lshr_b32 s60, s3, 3
    s_sub_u32 s60, s60, 20
    s_mul_i32 s60, s60, 928
    s_lshl_b32 s61, s36, 5
    s_add_u32 s60, s60, s61
    v_and_b32 v3, 31, v1
    v_add_u32 v3, s60, v3
    v_lshrrev_b32 v4, 5, v1
    v_lshlrev_b32 v5, 8, v3
    v_lshl_add_u32 v5, v4, 4, v5
    s_and_b32 s60, s2, 7
    s_lshl_b32 s60, s60, 5
    v_lshlrev_b32 v6, 1, v3
    buffer_load_dwordx4 v[64:67], v5, s[24:27], s60 offen
    buffer_load_ushort v80, v6, s[28:31], 0 offen offset:0
    s_add_u32 s60, s60, 65536
    buffer_load_dwordx4 v[68:71], v5, s[24:27], s60 offen
    buffer_load_ushort v81, v6, s[28:31], 0 offen offset:512
    s_add_u32 s60, s60, 65536
    buffer_load_dwordx4 v[72:75], v5, s[24:27], s60 offen
    buffer_load_ushort v82, v6, s[28:31], 0 offen offset:1024
    s_add_u32 s60, s60, 65536
    s_cmp_ge_u32 s36, 5
    s_cbranch_scc1 KSL_E
    buffer_load_dwordx4 v[76:79], v5, s[24:27], s60 offen
    buffer_load_ushort v83, v6, s[28:31], 0 offen offset:1536
KSL_E:
    v_mul_u32_u24 v84, 163840, v4
    v_lshl_add_u32 v84, v3, 3, v84
    s_and_b32 s60, s59, 0xfffff800
    s_add_u32 s60, s60, 39936
    v_mov_b32 v38, s48
    s_cmp_lg_u32 s40, 0
    s_cbranch_scc1 KS0_XP_X
    s_add_u32 s97, s46, 0
    s_mov_b32 s52, 0
    s_mov_b32 exec_hi, 0
KS0_XP_L:
    buffer_load_dwordx2 v[38:39], v62, s[8:11], s60 offen sc1
    s_waitcnt vmcnt(0)
    v_subrev_u32 v38, s97, v38
    v_cmp_gt_u32 vcc, 64, v38
    v_cmp_eq_u32 s[62:63], s47, v39
    s_nop 0
    s_and_b64 vcc, vcc, s[62:63]
    s_cmp_eq_u64 vcc, exec
    s_cbranch_scc1 KS0_XP_D
    s_sleep 1
    s_add_u32 s52, s52, 1
    s_cmp_lt_u32 s52, 1048576
    s_cbranch_scc1 KS0_XP_L
    s_mov_b32 s40, 1
KS0_XP_D:
    s_mov_b64 exec, -1
KS0_XP_X:
    v_cmp_ne_u32 vcc, s48, v38
    s_nop 0
    s_cmp_eq_u64 vcc, 0
    s_cselect_b32 s39, 1, 0
    s_waitcnt vmcnt(0)
    v_lshlrev_b32 v80, 16, v80
    v_lshlrev_b32 v4, 16, v64
    v_and_b32 v5, 0xffff0000, v64
    v_mul_f32 v4, v4, v80
    v_mul_f32 v5, v5, v80
    v_cvt_pk_bf16_f32 v64, v4, v5
    v_lshlrev_b32 v4, 16, v65
    v_and_b32 v5, 0xffff0000, v65
    v_mul_f32 v4, v4, v80
    v_mul_f32 v5, v5, v80
    v_cvt_pk_bf16_f32 v65, v4, v5
    v_lshlrev_b32 v4, 16, v66
    v_and_b32 v5, 0xffff0000, v66
    v_mul_f32 v4, v4, v80
    v_mul_f32 v5, v5, v80
    v_cvt_pk_bf16_f32 v66, v4, v5
    v_lshlrev_b32 v4, 16, v67
    v_and_b32 v5, 0xffff0000, v67
    v_mul_f32 v4, v4, v80
    v_mul_f32 v5, v5, v80
    v_cvt_pk_bf16_f32 v67, v4, v5
    v_lshlrev_b32 v81, 16, v81
    v_lshlrev_b32 v4, 16, v68
    v_and_b32 v5, 0xffff0000, v68
    v_mul_f32 v4, v4, v81
    v_mul_f32 v5, v5, v81
    v_cvt_pk_bf16_f32 v68, v4, v5
    v_lshlrev_b32 v4, 16, v69
    v_and_b32 v5, 0xffff0000, v69
    v_mul_f32 v4, v4, v81
    v_mul_f32 v5, v5, v81
    v_cvt_pk_bf16_f32 v69, v4, v5
    v_lshlrev_b32 v4, 16, v70
    v_and_b32 v5, 0xffff0000, v70
    v_mul_f32 v4, v4, v81
    v_mul_f32 v5, v5, v81
    v_cvt_pk_bf16_f32 v70, v4, v5
    v_lshlrev_b32 v4, 16, v71
    v_and_b32 v5, 0xffff0000, v71
    v_mul_f32 v4, v4, v81
    v_mul_f32 v5, v5, v81
    v_cvt_pk_bf16_f32 v71, v4, v5
    v_lshlrev_b32 v82, 16, v82
    v_lshlrev_b32 v4, 16, v72
    v_and_b32 v5, 0xffff0000, v72
    v_mul_f32 v4, v4, v82
    v_mul_f32 v5, v5, v82
    v_cvt_pk_bf16_f32 v72, v4, v5
    v_lshlrev_b32 v4, 16, v73
    v_and_b32 v5, 0xffff0000, v73
    v_mul_f32 v4, v4, v82
    v_mul_f32 v5, v5, v82
    v_cvt_pk_bf16_f32 v73, v4, v5
    v_lshlrev_b32 v4, 16, v74
    v_and_b32 v5, 0xffff0000, v74
    v_mul_f32 v4, v4, v82
    v_mul_f32 v5, v5, v82
    v_cvt_pk_bf16_f32 v74, v4, v5
    v_lshlrev_b32 v4, 16, v75
    v_and_b32 v5, 0xffff0000, v75
    v_mul_f32 v4, v4, v82
    v_mul_f32 v5, v5, v82
    v_cvt_pk_bf16_f32 v75, v4, v5
    v_lshlrev_b32 v83, 16, v83
    v_lshlrev_b32 v4, 16, v76
    v_and_b32 v5, 0xffff0000, v76
    v_mul_f32 v4, v4, v83
    v_mul_f32 v5, v5, v83
    v_cvt_pk_bf16_f32 v76, v4, v5
    v_lshlrev_b32 v4, 16, v77
    v_and_b32 v5, 0xffff0000, v77
    v_mul_f32 v4, v4, v83
    v_mul_f32 v5, v5, v83
    v_cvt_pk_bf16_f32 v77, v4, v5
    v_lshlrev_b32 v4, 16, v78
    v_and_b32 v5, 0xffff0000, v78
    v_mul_f32 v4, v4, v83
    v_mul_f32 v5, v5, v83
    v_cvt_pk_bf16_f32 v78, v4, v5
    v_lshlrev_b32 v4, 16, v79
    v_and_b32 v5, 0xffff0000, v79
    v_mul_f32 v4, v4, v83
    v_mul_f32 v5, v5, v83
    v_cvt_pk_bf16_f32 v79, v4, v5
    s_and_b32 s60, s2, 7
    s_mul_i32 s60, s60, 327680
    s_add_u32 s60, s60, 4194304
    s_add_u32 s16, s4, s60
    s_addc_u32 s17, s5, 0
    s_mov_b32 s18, 0x00050000
    s_mov_b32 s19, 0x20000
    s_mov_b32 s60, 81920
    v_add_u32 v6, 4096, v84
    s_cmp_eq_u32 s39, 0
    s_cbranch_scc1 KS0_ST_G
    buffer_store_dwordx2 v[64:65], v84, s[16:19], 0 offen offset:0
    buffer_store_dwordx2 v[66:67], v84, s[16:19], s60 offen offset:0
    buffer_store_dwordx2 v[68:69], v84, s[16:19], 0 offen offset:2048
    buffer_store_dwordx2 v[70:71], v84, s[16:19], s60 offen offset:2048
    buffer_store_dwordx2 v[72:73], v6, s[16:19], 0 offen offset:0
    buffer_store_dwordx2 v[74:75], v6, s[16:19], s60 offen offset:0
    s_cmp_ge_u32 s36, 5
    s_cbranch_scc1 KST4
    buffer_store_dwordx2 v[76:77], v6, s[16:19], 0 offen offset:2048
    buffer_store_dwordx2 v[78:79], v6, s[16:19], s60 offen offset:2048
KST4:
    s_branch KS0_ST_J
KS0_ST_G:
    buffer_store_dwordx2 v[64:65], v84, s[16:19], 0 offen offset:0 sc1
    buffer_store_dwordx2 v[66:67], v84, s[16:19], s60 offen offset:0 sc1
    buffer_store_dwordx2 v[68:69], v84, s[16:19], 0 offen offset:2048 sc1
    buffer_store_dwordx2 v[70:71], v84, s[16:19], s60 offen offset:2048 sc1
    buffer_store_dwordx2 v[72:73], v6, s[16:19], 0 offen offset:0 sc1
    buffer_store_dwordx2 v[74:75], v6, s[16:19], s60 offen offset:0 sc1
    s_cmp_ge_u32 s36, 5
    s_cbranch_scc1 KST5
    buffer_store_dwordx2 v[76:77], v6, s[16:19], 0 offen offset:2048 sc1
    buffer_store_dwordx2 v[78:79], v6, s[16:19], s60 offen offset:2048 sc1
KST5:
KS0_ST_J:
    s_add_u32 s60, s59, 12288
    v_mov_b32 v4, s46
    v_mov_b32 v5, s47
    v_mov_b32 v3, 0
    s_waitcnt vmcnt(0)
    s_barrier
    s_cmp_lg_u32 s36, 1
    s_cbranch_scc1 KS0_NF
    s_mov_b64 exec, 1
    s_cmp_eq_u32 s39, 0
    s_cbranch_scc1 KS0_FS_G
    buffer_store_dwordx2 v[4:5], v3, s[8:11], s60 offen
    s_branch KS0_FS_J
KS0_FS_G:
    buffer_store_dwordx2 v[4:5], v3, s[8:11], s60 offen sc1
KS0_FS_J:
    s_mov_b64 exec, -1
KS0_NF:
KA_M:
    s_add_u32 s12, s4, s57
    s_addc_u32 s13, s5, 0
    s_mov_b32 s14, 0x00013880
    s_mov_b32 s15, 0x20000
    s_add_u32 s16, s4, s57
    s_addc_u32 s17, s5, 0
    s_mov_b32 s18, 0x00013880
    s_mov_b32 s19, 0x20000
    s_add_u32 s20, s4, 0x01d00000
    s_addc_u32 s21, s5, 0
    s_mov_b32 s22, 0x01388000
    s_mov_b32 s23, 0x20000
    s_cmp_lt_u32 s36, 4
    s_cbranch_scc1 KTL6
    v_and_b32 v3, 7, v1
    v_lshlrev_b32 v3, 8, v3
    v_lshrrev_b32 v4, 3, v1
    v_lshl_add_u32 v3, v4, 4, v3
    s_mul_i32 s60, s2, 5
    s_add_u32 s60, s60, s36
    s_sub_u32 s60, s60, 4
    s_lshl_b32 s60, s60, 11
    s_add_u32 s61, s60, 8192
    buffer_load_dwordx4 v[44:47], v3, s[24:27], s60 offen offset:0
    buffer_load_dwordx4 v[48:51], v3, s[24:27], s60 offen offset:128
    s_cmp_lg_u32 s36, 4
    s_cbranch_scc1 KTL6
    buffer_load_dwordx4 v[52:55], v3, s[24:27], s61 offen offset:0
    buffer_load_dwordx4 v[56:59], v3, s[24:27], s61 offen offset:128
KTL6:
    v_lshrrev_b32 v3, 2, v14
    buffer_load_ushort v8, v3, s[28:31], 0 offen offset:0
    buffer_load_ushort v9, v3, s[28:31], 0 offen offset:1024
    buffer_load_ushort v10, v3, s[28:31], 0 offen offset:2048
    s_and_b32 s60, s59, 0xfffff800
    s_add_u32 s60, s60, 39936
    v_mov_b32 v38, s48
    s_cmp_lg_u32 s40, 0
    s_cbranch_scc1 KI_XP_X
    s_add_u32 s97, s46, 0
    s_mov_b32 s52, 0
    s_mov_b32 exec_hi, 0
KI_XP_L:
    buffer_load_dwordx2 v[38:39], v62, s[8:11], s60 offen sc1
    s_waitcnt vmcnt(0)
    v_subrev_u32 v38, s97, v38
    v_cmp_gt_u32 vcc, 64, v38
    v_cmp_eq_u32 s[62:63], s47, v39
    s_nop 0
    s_and_b64 vcc, vcc, s[62:63]
    s_cmp_eq_u64 vcc, exec
    s_cbranch_scc1 KI_XP_D
    s_sleep 1
    s_add_u32 s52, s52, 1
    s_cmp_lt_u32 s52, 1048576
    s_cbranch_scc1 KI_XP_L
    s_mov_b32 s40, 1
KI_XP_D:
    s_mov_b64 exec, -1
KI_XP_X:
    v_cmp_ne_u32 vcc, s48, v38
    s_nop 0
    s_cmp_eq_u64 vcc, 0
    s_cselect_b32 s39, 1, 0
    s_cmp_ge_u32 s3, 157
    s_cbranch_scc1 KI
    s_bfe_u32 s72, s47, 0x70000
    s_lshl_b32 s72, s72, 16
    s_bfe_u32 s73, s47, 0x70007
    s_lshl_b32 s73, s73, 16
    s_or_b32 s73, s73, 16384
    s_bfe_u32 s74, s47, 0x7000e
    s_lshl_b32 s74, s74, 16
    s_or_b32 s74, s74, 32768
    s_bfe_u32 s75, s47, 0x70015
    s_lshl_b32 s75, s75, 16
    s_or_b32 s75, s75, 49152
    v_lshrrev_b32 v4, 3, v0
    v_and_b32 v5, 7, v0
    v_mul_u32_u24 v4, 20096, v4
    v_lshl_add_u32 v40, v5, 4, v4
    v_lshrrev_b32 v4, 4, v0
    v_min_u32 v4, 29, v4
    v_and_b32 v5, 15, v0
    v_mul_u32_u24 v4, 20096, v4
    v_lshl_add_u32 v41, v5, 3, v4
    v_and_b32 v5, 1, v0
    v_cmp_eq_u32 vcc, 0, v5
    v_mov_b32 v3, s72
    v_mov_b32 v4, s74
    v_cndmask_b32 v42, v4, v3, vcc
    v_mov_b32 v3, s73
    v_mov_b32 v4, s75
    v_cndmask_b32 v43, v4, v3, vcc
    s_mul_i32 s49, s3, 128
    s_add_u32 s49, s49, 2097152
    s_add_u32 s50, s49, 1286144
    v_cmp_le_u32 s[60:61], s56, v0
    s_mov_b32 s52, 0
    s_mov_b32 s51, 0x7fc000
KB_CL:
    buffer_load_dwordx4 v[64:67], v40, s[8:11], s49 offen sc1
    buffer_load_dwordx2 v[68:69], v41, s[8:11], s50 offen sc1
    s_waitcnt vmcnt(1)
    v_xor_b32 v64, s72, v64
    v_xor_b32 v65, s73, v65
    v_xor_b32 v66, s74, v66
    v_xor_b32 v67, s75, v67
    v_or3_b32 v3, v64, v65, v66
    s_waitcnt vmcnt(0)
    v_xor_b32 v68, v42, v68
    v_xor_b32 v69, v43, v69
    v_or3_b32 v4, v67, v68, v69
    v_or_b32 v3, v3, v4
    v_and_b32 v3, s51, v3
    v_cmp_ne_u32 vcc, 0, v3
    s_cbranch_vccz KB_CD
    s_add_u32 s52, s52, 1
    s_cmp_lt_u32 s52, 1048576
    s_cbranch_scc1 KB_CL
    s_mov_b32 s40, 1
KB_CD:
    v_mov_b32 v3, 0xe0000000
    v_cndmask_b32 v68, v68, v3, s[60:61]
    v_cndmask_b32 v69, v69, v3, s[60:61]
    s_mul_i32 s51, s36, 1536
    s_add_u32 s51, s51, 80000
    s_mov_b32 s50, s51
    v_mov_b32 v6, 74
    v_mov_b32 v7, 1
    v_mov_b32 v5, 0x7c
    v_mov_b32 v112, 0x7fff8
    v_mov_b32 v113, 0x3e
    v_lshrrev_b32 v3, 23, v64
    v_alignbit_b32 v104, v6, v64, 21
    v_sub_u32 v88, v64, v3
    v_and_b32 v104, -4, v104
    v_lshlrev_b32 v80, v88, v7
    ds_or_rtn_b32 v72, v104, v80
    v_lshrrev_b32 v3, 23, v65
    v_alignbit_b32 v105, v6, v65, 21
    v_sub_u32 v89, v65, v3
    v_and_b32 v105, -4, v105
    v_lshlrev_b32 v81, v89, v7
    ds_or_rtn_b32 v73, v105, v81
    v_lshrrev_b32 v3, 23, v66
    v_alignbit_b32 v106, v6, v66, 21
    v_sub_u32 v90, v66, v3
    v_and_b32 v106, -4, v106
    v_lshlrev_b32 v82, v90, v7
    ds_or_rtn_b32 v74, v106, v82
    v_lshrrev_b32 v3, 23, v67
    v_alignbit_b32 v107, v6, v67, 21
    v_sub_u32 v91, v67, v3
    v_and_b32 v107, -4, v107
    v_lshlrev_b32 v83, v91, v7
    ds_or_rtn_b32 v75, v107, v83
    v_lshrrev_b32 v3, 23, v68
    v_alignbit_b32 v108, v6, v68, 21
    v_sub_u32 v92, v68, v3
    v_and_b32 v108, -4, v108
    v_lshlrev_b32 v84, v92, v7
    ds_or_rtn_b32 v76, v108, v84
    v_lshrrev_b32 v3, 23, v69
    v_alignbit_b32 v109, v6, v69, 21
    v_sub_u32 v93, v69, v3
    v_and_b32 v109, -4, v109
    v_lshlrev_b32 v85, v93, v7
    ds_or_rtn_b32 v77, v109, v85
    v_alignbit_b32 v3, v7, v64, 15
    v_lshlrev_b32 v88, 1, v88
    v_bfi_b32 v88, v113, v88, v3
    v_lshlrev_b32 v3, 2, v64
    v_bfi_b32 v96, v5, v3, v104
    v_alignbit_b32 v3, v7, v65, 15
    v_lshlrev_b32 v89, 1, v89
    v_bfi_b32 v89, v113, v89, v3
    v_lshlrev_b32 v3, 2, v65
    v_bfi_b32 v97, v5, v3, v105
    v_alignbit_b32 v3, v7, v66, 15
    v_lshlrev_b32 v90, 1, v90
    v_bfi_b32 v90, v113, v90, v3
    v_lshlrev_b32 v3, 2, v66
    v_bfi_b32 v98, v5, v3, v106
    v_alignbit_b32 v3, v7, v67, 15
    v_lshlrev_b32 v91, 1, v91
    v_bfi_b32 v91, v113, v91, v3
    v_lshlrev_b32 v3, 2, v67
    v_bfi_b32 v99, v5, v3, v107
    v_alignbit_b32 v3, v7, v68, 15
    v_lshlrev_b32 v92, 1, v92
    v_bfi_b32 v92, v113, v92, v3
    v_lshlrev_b32 v3, 2, v68
    v_bfi_b32 v100, v5, v3, v108
    v_alignbit_b32 v3, v7, v69, 15
    v_lshlrev_b32 v93, 1, v93
    v_bfi_b32 v93, v113, v93, v3
    v_lshlrev_b32 v3, 2, v69
    v_bfi_b32 v101, v5, v3, v109
    s_waitcnt lgkmcnt(5)
    v_and_b32 v3, v72, v80
    v_cmp_ne_u32 vcc, 0, v3
    s_nop 1
    v_mbcnt_lo_u32_b32 v3, vcc_lo, 0
    v_cndmask_b32 v88, v88, v112, vcc
    v_mbcnt_hi_u32_b32 v3, vcc_hi, v3
    v_cndmask_b32 v80, v80, 0, vcc
    ds_write_b16 v88, v64
    v_lshl_add_u32 v3, v3, 2, s51
    ds_or_b32 v96, v80 offset:256
    v_cndmask_b32 v88, v112, v3, vcc
    s_bcnt1_i32_b64 s49, vcc
    ds_write_b32 v88, v64
    s_lshl2_add_u32 s51, s49, s51
    s_waitcnt lgkmcnt(7)
    v_and_b32 v3, v73, v81
    v_cmp_ne_u32 vcc, 0, v3
    s_nop 1
    v_mbcnt_lo_u32_b32 v3, vcc_lo, 0
    v_cndmask_b32 v89, v89, v112, vcc
    v_mbcnt_hi_u32_b32 v3, vcc_hi, v3
    v_cndmask_b32 v81, v81, 0, vcc
    ds_write_b16 v89, v65
    v_lshl_add_u32 v3, v3, 2, s51
    ds_or_b32 v97, v81 offset:256
    v_cndmask_b32 v89, v112, v3, vcc
    s_bcnt1_i32_b64 s49, vcc
    ds_write_b32 v89, v65
    s_lshl2_add_u32 s51, s49, s51
    s_waitcnt lgkmcnt(9)
    v_and_b32 v3, v74, v82
    v_cmp_ne_u32 vcc, 0, v3
    s_nop 1
    v_mbcnt_lo_u32_b32 v3, vcc_lo, 0
    v_cndmask_b32 v90, v90, v112, vcc
    v_mbcnt_hi_u32_b32 v3, vcc_hi, v3
    v_cndmask_b32 v82, v82, 0, vcc
    ds_write_b16 v90, v66
    v_lshl_add_u32 v3, v3, 2, s51
    ds_or_b32 v98, v82 offset:256
    v_cndmask_b32 v90, v112, v3, vcc
    s_bcnt1_i32_b64 s49, vcc
    ds_write_b32 v90, v66
    s_lshl2_add_u32 s51, s49, s51
    s_waitcnt lgkmcnt(11)
    v_and_b32 v3, v75, v83
    v_cmp_ne_u32 vcc, 0, v3
    s_nop 1
    v_mbcnt_lo_u32_b32 v3, vcc_lo, 0
    v_cndmask_b32 v91, v91, v112, vcc
    v_mbcnt_hi_u32_b32 v3, vcc_hi, v3
    v_cndmask_b32 v83, v83, 0, vcc
    ds_write_b16 v91, v67
    v_lshl_add_u32 v3, v3, 2, s51
    ds_or_b32 v99, v83 offset:256
    v_cndmask_b32 v91, v112, v3, vcc
    s_bcnt1_i32_b64 s49, vcc
    ds_write_b32 v91, v67
    s_lshl2_add_u32 s51, s49, s51
    s_waitcnt lgkmcnt(13)
    v_and_b32 v3, v76, v84
    v_cmp_ne_u32 vcc, 0, v3
    s_nop 1
    v_mbcnt_lo_u32_b32 v3, vcc_lo, 0
    v_cndmask_b32 v92, v92, v112, vcc
    v_mbcnt_hi_u32_b32 v3, vcc_hi, v3
    v_cndmask_b32 v84, v84, 0, vcc
    ds_write_b16 v92, v68
    v_lshl_add_u32 v3, v3, 2, s51
    ds_or_b32 v100, v84 offset:256
    v_cndmask_b32 v92, v112, v3, vcc
    s_bcnt1_i32_b64 s49, vcc
    ds_write_b32 v92, v68
    s_lshl2_add_u32 s51, s49, s51
    s_waitcnt lgkmcnt(15)
    v_and_b32 v3, v77, v85
    v_cmp_ne_u32 vcc, 0, v3
    s_nop 1
    v_mbcnt_lo_u32_b32 v3, vcc_lo, 0
    v_cndmask_b32 v93, v93, v112, vcc
    v_mbcnt_hi_u32_b32 v3, vcc_hi, v3
    v_cndmask_b32 v85, v85, 0, vcc
    ds_write_b16 v93, v69
    v_lshl_add_u32 v3, v3, 2, s51
    ds_or_b32 v101, v85 offset:256
    v_cndmask_b32 v93, v112, v3, vcc
    s_bcnt1_i32_b64 s49, vcc
    ds_write_b32 v93, v69
    s_lshl2_add_u32 s51, s49, s51
    v_lshrrev_b32 v3, 29, v67
    v_lshrrev_b32 v4, 29, v69
    v_cmp_eq_u32 vcc, 6, v3
    v_cmp_eq_u32 s[62:63], 6, v4
    s_nop 0
    s_or_b64 vcc, vcc, s[62:63]
    v_mov_b32 v3, 64
    v_mov_b32 v4, 151552
    s_mov_b64 exec, vcc
    ds_max_u32 v4, v3 offset:512
    s_mov_b64 exec, -1
    v_lshl_add_u32 v3, v1, 2, s50
    v_cmp_gt_u32 s[64:65], s51, v3
    ds_read_b32 v64, v3
    s_add_u32 s50, s50, 256
    s_waitcnt lgkmcnt(0)
    v_alignbit_b32 v65, v6, v64, 21
    v_and_b32 v65, -4, v65
    v_lshlrev_b32 v3, 2, v64
    v_bfi_b32 v66, v5, v3, v65
    v_alignbit_b32 v72, v7, v64, 15
    v_and_b32 v72, 0xffffff00, v72
    v_lshrrev_b32 v70, 5, v64
    v_mul_u32_u24 v70, 7, v70
    v_add_u32 v70, v70, v1
    s_barrier
KB_P2:
    s_mov_b64 exec, s[64:65]
    s_cbranch_execz KB_P2E
    ds_read_b32 v67, v65
    ds_read_b32 v68, v66 offset:256
    s_mov_b32 s52, 0
KB_P2R:
    s_waitcnt lgkmcnt(0)
    v_or_b32 v69, v67, v68
    v_cmp_eq_u32 vcc, -1, v69
    s_nop 1
    v_cndmask_b32 v69, v69, v67, vcc
    v_cndmask_b32 v73, -1, 0, vcc
    v_not_b32 v69, v69
    v_alignbit_b32 v3, v69, v69, v70
    v_cmp_eq_u32 vcc, 0, v69
    s_cbranch_vccnz KB_P2O
KB_P2N:
    v_ffbl_b32 v3, v3
    v_add_u32 v3, v3, v70
    v_lshlrev_b32 v71, v3, v7
    ds_or_rtn_b32 v67, v65, v71
    ds_or_rtn_b32 v68, v66, v71 offset:256
    v_and_b32 v3, 31, v3
    v_lshl_add_u32 v3, v3, 1, v72
    v_add_u32 v70, 11, v70
    s_add_u32 s52, s52, 1
    s_cmp_le_u32 s52, 2
    s_cselect_b32 s49, -1, 0
    s_waitcnt lgkmcnt(0)
    v_and_b32 v4, s49, v68
    v_and_b32 v4, v4, v73
    v_or_b32 v4, v4, v67
    v_and_b32 v4, v4, v71
    v_cmp_eq_u32 vcc, 0, v4
    v_and_b32 v4, v67, v71
    v_cmp_eq_u32 s[62:63], 0, v4
    s_and_saveexec_b64 s[60:61], vcc
    ds_write_b16 v3, v64
    s_andn2_b64 exec, s[62:63], vcc
    ds_xor_b32 v65, v71
    s_andn2_b64 exec, s[60:61], vcc
    s_cbranch_execnz KB_P2R
KB_P2X:
    s_mov_b64 exec, -1
    s_cmp_ge_u32 s50, s51
    s_cbranch_scc1 KB_P2E
    v_lshl_add_u32 v3, v1, 2, s50
    v_cmp_gt_u32 s[64:65], s51, v3
    ds_read_b32 v64, v3
    s_add_u32 s50, s50, 256
    s_waitcnt lgkmcnt(0)
    v_alignbit_b32 v65, v6, v64, 21
    v_and_b32 v65, -4, v65
    v_lshlrev_b32 v3, 2, v64
    v_bfi_b32 v66, v5, v3, v65
    v_alignbit_b32 v72, v7, v64, 15
    v_and_b32 v72, 0xffffff00, v72
    v_lshrrev_b32 v70, 5, v64
    v_mul_u32_u24 v70, 7, v70
    v_add_u32 v70, v70, v1
    s_branch KB_P2
KB_P2O:
    s_and_saveexec_b64 s[60:61], vcc
    ds_add_rtn_u32 v4, v65, v7 offset:512
    s_waitcnt lgkmcnt(0)
    v_add_u32 v4, 28, v4
    v_cmp_gt_u32 s[62:63], 40, v4
    v_lshl_add_u32 v4, v4, 1, v72
    s_mov_b64 exec, s[62:63]
    ds_write_b16 v4, v64
    s_andn2_b64 exec, s[60:61], vcc
    s_cbranch_execnz KB_P2N
    s_branch KB_P2X
KB_P2E:
    s_mov_b64 exec, -1
    s_waitcnt lgkmcnt(0)
    s_barrier
    s_cmp_ge_u32 s36, 5
    s_cbranch_scc1 KB_EF
    s_lshl_b32 s49, s36, 4
    s_add_u32 s49, s49, 131072
    v_lshl_add_u32 v3, v1, 8, s49
    ds_read_b128 v[64:67], v3
    v_lshlrev_b32 v4, 2, v1
    v_add_u32 v4, 151552, v4
    ds_read_b32 v5, v4 offset:512
    s_mul_i32 s49, s3, 5120
    s_lshl_b32 s50, s36, 10
    s_add_u32 s49, s49, s50
    s_add_u32 s49, s49, 262144
    v_lshlrev_b32 v6, 3, v1
    s_waitcnt lgkmcnt(1)
    s_cmp_eq_u32 s36, 3
    s_cbranch_scc1 KB_E3
    buffer_store_dwordx4 v[64:67], v2, s[8:11], s49 offen sc1
    s_branch KB_E4
KB_E3:
    buffer_store_dwordx2 v[64:65], v6, s[8:11], s49 offen sc1
    buffer_store_dwordx2 v[66:67], v6, s[8:11], s49 offen offset:512 sc1
KB_E4:
    s_waitcnt lgkmcnt(0)
    v_max_u32_dpp v5, v5, v5 quad_perm:[1,0,3,2] row_mask:0xf bank_mask:0xf
    s_nop 1
    v_max_u32_dpp v5, v5, v5 quad_perm:[2,3,0,1] row_mask:0xf bank_mask:0xf
    s_nop 1
    v_max_u32_dpp v5, v5, v5 row_half_mirror row_mask:0xf bank_mask:0xf
    s_nop 1
    v_max_u32_dpp v5, v5, v5 row_mirror row_mask:0xf bank_mask:0xf
    v_mov_b32 v4, v5
    s_nop 1
    v_permlane16_swap_b32 v5, v4
    v_max_u32 v5, v5, v4
    v_mov_b32 v4, v5
    s_nop 1
    v_permlane32_swap_b32 v5, v4
    v_max_u32 v5, v5, v4
    s_nop 0
    v_readfirstlane_b32 s50, v5
    s_nop 0
    s_add_u32 s50, s50, 28
    s_cmp_gt_u32 s50, 40
    s_cmov_b32 s50, 63
    s_lshl_b32 s49, s3, 6
    s_add_u32 s49, s49, 28672
KB_EF:
    s_waitcnt vmcnt(0)
    s_barrier
    s_cmp_lg_u32 s36, 0
    s_cbranch_scc1 KB_BP
    s_add_u32 s52, s46, s50
    v_mov_b32 v4, s52
    v_mov_b32 v5, s47
    v_mov_b32 v3, 0
    s_mov_b64 exec, 1
    buffer_store_dwordx2 v[4:5], v3, s[8:11], s49 offen sc1
    s_mov_b64 exec, -1
KB_BP:
KI:
    s_and_b32 s49, s59, 0xfffff800
    s_add_u32 s49, s49, 12352
    s_cmp_lg_u32 s40, 0
    s_cbranch_scc1 KB_TP_X
    s_add_u32 s97, s46, 0
    s_mov_b32 s52, 0
    s_mov_b64 exec, 0x7ff
KB_TP_L:
    buffer_load_dwordx2 v[60:61], v62, s[8:11], s49 offen sc1
    s_waitcnt vmcnt(0)
    v_subrev_u32 v60, s97, v60
    v_cmp_gt_u32 vcc, 64, v60
    v_cmp_eq_u32 s[62:63], s47, v61
    s_nop 0
    s_and_b64 vcc, vcc, s[62:63]
    s_cmp_eq_u64 vcc, exec
    s_cbranch_scc1 KB_TP_D
    s_sleep 1
    s_add_u32 s52, s52, 1
    s_cmp_lt_u32 s52, 1048576
    s_cbranch_scc1 KB_TP_L
    s_mov_b32 s40, 1
KB_TP_D:
    s_mov_b64 exec, -1
KB_TP_X:
    s_add_u32 s49, s53, 4096
    s_add_u32 s50, s53, 8192
    s_mov_b32 m0, s53
    s_nop 0
    buffer_load_dwordx4 v2, s[12:15], s53 offen offset:0 sc1 lds
    buffer_load_dwordx4 v2, s[12:15], s53 offen offset:1024 sc1 lds
    buffer_load_dwordx4 v2, s[12:15], s53 offen offset:2048 sc1 lds
    buffer_load_dwordx4 v2, s[12:15], s53 offen offset:3072 sc1 lds
    s_mov_b32 m0, s49
    s_nop 0
    buffer_load_dwordx4 v2, s[12:15], s49 offen offset:0 sc1 lds
    buffer_load_dwordx4 v2, s[12:15], s49 offen offset:1024 sc1 lds
    buffer_load_dwordx4 v2, s[12:15], s49 offen offset:2048 sc1 lds
    buffer_load_dwordx4 v2, s[12:15], s49 offen offset:3072 sc1 lds
    s_mov_b32 m0, s50
    s_cmp_eq_u32 s36, 7
    s_cbranch_scc1 KB_F_7
    buffer_load_dwordx4 v2, s[12:15], s50 offen sc1 lds
    buffer_load_dwordx4 v2, s[12:15], s50 offen offset:1024 sc1 lds
    s_branch KB_F_E
KB_F_7:
    s_mov_b64 exec, 0xff
    buffer_load_dwordx4 v2, s[12:15], s50 offen sc1 lds
    s_mov_b64 exec, -1
KB_F_E:
    s_mul_i32 s49, s38, 20
    s_add_u32 s49, s49, s36
    s_add_u32 s50, s49, 16
    s_mov_b32 s60, 7
    s_cmp_ge_u32 s36, 4
    s_cmov_b32 s60, 3
    s_cmp_ge_u32 s50, 157
    s_cmov_b32 s60, 3
    s_mov_b32 s61, 0
    s_lshl_b32 s49, s49, 6
    s_add_u32 s49, s49, 28672
    v_lshlrev_b32 v6, 9, v1
    v_mov_b32 v60, 0
    s_cmp_lg_u32 s40, 0
    s_cbranch_scc1 KI_BP_X
    s_add_u32 s97, s46, 0
    s_mov_b32 s52, 0
    s_mov_b64 exec, s[60:61]
KI_BP_L:
    buffer_load_dwordx2 v[60:61], v6, s[8:11], s49 offen sc1
    s_waitcnt vmcnt(0)
    v_subrev_u32 v60, s97, v60
    v_cmp_gt_u32 vcc, 64, v60
    v_cmp_eq_u32 s[62:63], s47, v61
    s_nop 0
    s_and_b64 vcc, vcc, s[62:63]
    s_cmp_eq_u64 vcc, exec
    s_cbranch_scc1 KI_BP_D
    s_sleep 8
    s_add_u32 s52, s52, 1
    s_cmp_lt_u32 s52, 1048576
    s_cbranch_scc1 KI_BP_L
    s_mov_b32 s40, 1
KI_BP_D:
    s_mov_b64 exec, -1
KI_BP_X:
    v_readlane_b32 s42, v60, 0
    v_readlane_b32 s43, v60, 1
    v_readlane_b32 s44, v60, 2
    v_cmp_lt_u32 vcc, 40, v60
    v_mov_b32 v6, 97408
    v_mov_b32 v7, 1
    s_mov_b64 exec, vcc
    ds_write_b32 v6, v7
    s_mov_b64 exec, -1
    s_mul_i32 s49, s38, 20
    s_add_u32 s49, s49, s36
    s_mul_i32 s49, s49, 5120
    s_add_u32 s49, s49, 262144
    v_lshlrev_b32 v7, 3, v1
    s_cmp_le_u32 s42, 28
    s_cbranch_scc1 KI_X0
    s_add_u32 s50, s49, 1024
    buffer_load_dwordx2 v[78:79], v7, s[8:11], s50 offen offset:2560 sc1
    buffer_load_dwordx4 v[80:83], v2, s[8:11], s50 offen offset:3072 sc1
KI_X0:
    s_cmp_le_u32 s43, 28
    s_cbranch_scc1 KI_X1
    s_add_u32 s50, s49, 41984
    buffer_load_dwordx2 v[98:99], v7, s[8:11], s50 offen offset:2560 sc1
    buffer_load_dwordx4 v[100:103], v2, s[8:11], s50 offen offset:3072 sc1
KI_X1:
    s_cmp_le_u32 s44, 28
    s_cbranch_scc1 KI_X2
    s_add_u32 s50, s49, 82944
    buffer_load_dwordx2 v[118:119], v7, s[8:11], s50 offen offset:2560 sc1
    buffer_load_dwordx4 v[120:123], v2, s[8:11], s50 offen offset:3072 sc1
KI_X2:
    buffer_load_dwordx4 v[64:67], v2, s[8:11], s49 offen offset:0 sc1
    buffer_load_dwordx4 v[68:71], v2, s[8:11], s49 offen offset:1024 sc1
    buffer_load_dwordx4 v[72:75], v2, s[8:11], s49 offen offset:2048 sc1
    buffer_load_dwordx2 v[76:77], v7, s[8:11], s49 offen offset:3072 sc1
    s_add_u32 s49, s49, 40960
    buffer_load_dwordx4 v[84:87], v2, s[8:11], s49 offen offset:0 sc1
    buffer_load_dwordx4 v[88:91], v2, s[8:11], s49 offen offset:1024 sc1
    buffer_load_dwordx4 v[92:95], v2, s[8:11], s49 offen offset:2048 sc1
    buffer_load_dwordx2 v[96:97], v7, s[8:11], s49 offen offset:3072 sc1
    s_add_u32 s49, s49, 40960
    s_cmp_eq_u32 s44, 0
    s_cbranch_scc1 KI_L2
    buffer_load_dwordx4 v[104:107], v2, s[8:11], s49 offen offset:0 sc1
    buffer_load_dwordx4 v[108:111], v2, s[8:11], s49 offen offset:1024 sc1
    buffer_load_dwordx4 v[112:115], v2, s[8:11], s49 offen offset:2048 sc1
    buffer_load_dwordx2 v[116:117], v7, s[8:11], s49 offen offset:3072 sc1
KI_L2:
    v_mov_b32 v5, 0x7fff8
    v_bfrev_b32 v7, 1
    s_mov_b32 s49, 80000
    s_cmp_ge_u32 s36, 4
    s_cselect_b32 s50, 0, s49
    v_add_u32 v3, 0, v14
    v_add_u32 v4, 0, v15
    v_cmp_gt_u32 vcc, s49, v3
    s_nop 1
    v_cndmask_b32 v212, v5, v3, vcc
    v_cndmask_b32 v248, v7, v4, vcc
    v_add_u32 v3, 4096, v14
    v_add_u32 v4, 131072, v15
    v_cmp_gt_u32 vcc, s49, v3
    s_nop 1
    v_cndmask_b32 v213, v5, v3, vcc
    v_cndmask_b32 v249, v7, v4, vcc
    v_add_u32 v3, 8192, v14
    v_add_u32 v4, 262144, v15
    v_cmp_gt_u32 vcc, s50, v3
    s_nop 1
    v_cndmask_b32 v214, v5, v3, vcc
    v_cndmask_b32 v250, v7, v4, vcc
    s_max_u32 s49, s42, s43
    s_max_u32 s49, s49, s44
    s_cmp_gt_u32 s49, 28
    s_cselect_b32 s64, 1, 0
    s_mov_b32 s76, 0x7f000000
    s_mov_b32 s65, 1048576
    s_cmp_lg_u32 s40, 0
    s_cmov_b32 s65, 0
    s_mov_b32 s41, 1
    s_mov_b32 s58, 1
    v_lshlrev_b32 v222, 3, v1
    s_lshl_b32 s49, s36, 3
    s_add_u32 s54, s54, s49
    s_add_u32 s54, s54, 56320
    s_add_u32 s55, s55, 56320
    s_lshl_b32 s98, s38, 5
    s_add_u32 s98, s98, s37
    s_lshl_b32 s98, s98, 6
    s_add_u32 s98, s98, 72704
    s_lshr_b32 s94, s2, 5
    s_lshl_b32 s94, s94, 11
    s_add_u32 s94, s94, 56320
    s_mov_b32 s79, 0
    s_and_b32 s49, s36, 3
    s_mul_i32 s95, s2, 5
    s_add_u32 s95, s95, s49
    s_lshl_b32 s95, s95, 11
    s_mul_i32 s96, s49, 14448
    s_cmp_lt_u32 s36, 4
    s_cmov_b32 s58, 8
    s_cmp_ge_u32 s2, 250
    s_cmov_b32 s58, 8
    v_mov_b32 v60, 0
    v_mov_b32 v61, 0
    v_mov_b32 v20, 0
    v_mov_b32 v21, 0
    v_mov_b32 v22, 0
    v_mov_b32 v23, 0
    v_mov_b32 v24, 0
    v_mov_b32 v25, 0
    v_mov_b32 v26, 0
    v_mov_b32 v27, 0
    v_mov_b32 v28, 0
    v_mov_b32 v29, 0
    v_mov_b32 v30, 0
    v_mov_b32 v31, 0
    s_and_b32 s49, s41, 1
    s_add_u32 s50, s41, 2
    s_cmp_eq_u32 s39, 0
    s_cmov_b32 s49, s50
    s_mul_i32 s49, s49, 2621440
    s_add_u32 s49, s49, s57
    s_add_u32 s16, s4, s49
    s_addc_u32 s17, s5, 0
    v_lshlrev_b32 v8, 16, v8
    v_mul_f32 v11, v8, v8
    v_lshlrev_b32 v9, 16, v9
    v_mul_f32 v12, v9, v9
    v_lshlrev_b32 v10, 16, v10
    v_mul_f32 v13, v10, v10
    s_waitcnt lgkmcnt(0)
    s_barrier
    ds_read_b32 v7, v6
    s_waitcnt lgkmcnt(0)
    v_readfirstlane_b32 s45, v7
    s_nop 0
    s_cmp_lg_u32 s45, 0
    s_cmov_b32 s64, 2
    s_cbranch_scc1 KI_N0
    s_cmp_lt_u32 s36, 4
    s_cbranch_scc1 KI_N0
    v_and_b32 v3, 7, v1
    v_lshlrev_b32 v3, 3, v3
    v_lshrrev_b32 v4, 3, v1
    v_lshl_add_u32 v3, v4, 7, v3
    s_and_b32 s49, s36, 3
    s_mul_i32 s49, s49, 14448
    s_add_u32 s49, s49, 80000
    v_add_u32 v3, s49, v3
    ds_write_b64 v3, v[44:45] offset:0
    ds_write_b64 v3, v[46:47] offset:64
    ds_write_b64 v3, v[48:49] offset:1024
    ds_write_b64 v3, v[50:51] offset:1088
    s_cmp_lg_u32 s36, 4
    s_cbranch_scc1 KI_T0
    ds_write_b64 v3, v[52:53] offset:57792
    ds_write_b64 v3, v[54:55] offset:57856
    ds_write_b64 v3, v[56:57] offset:58816
    ds_write_b64 v3, v[58:59] offset:58880
KI_T0:
KI_N0:
    s_cmp_eq_u32 s44, 0
    s_cbranch_scc1 KI_E2
    s_waitcnt vmcnt(11)
    v_lshlrev_b32_sdwa v128, 3, v64 dst_sel:DWORD dst_unused:UNUSED_PAD src0_sel:DWORD src1_sel:WORD_0
    v_lshlrev_b32_sdwa v129, 3, v64 dst_sel:DWORD dst_unused:UNUSED_PAD src0_sel:DWORD src1_sel:WORD_1
    v_lshlrev_b32_sdwa v130, 3, v65 dst_sel:DWORD dst_unused:UNUSED_PAD src0_sel:DWORD src1_sel:WORD_0
    v_lshlrev_b32_sdwa v131, 3, v65 dst_sel:DWORD dst_unused:UNUSED_PAD src0_sel:DWORD src1_sel:WORD_1
    v_lshlrev_b32_sdwa v132, 3, v66 dst_sel:DWORD dst_unused:UNUSED_PAD src0_sel:DWORD src1_sel:WORD_0
    v_lshlrev_b32_sdwa v133, 3, v66 dst_sel:DWORD dst_unused:UNUSED_PAD src0_sel:DWORD src1_sel:WORD_1
    v_lshlrev_b32_sdwa v134, 3, v67 dst_sel:DWORD dst_unused:UNUSED_PAD src0_sel:DWORD src1_sel:WORD_0
    v_lshlrev_b32_sdwa v135, 3, v67 dst_sel:DWORD dst_unused:UNUSED_PAD src0_sel:DWORD src1_sel:WORD_1
    s_waitcnt vmcnt(10)
    v_lshlrev_b32_sdwa v136, 3, v68 dst_sel:DWORD dst_unused:UNUSED_PAD src0_sel:DWORD src1_sel:WORD_0
    v_lshlrev_b32_sdwa v137, 3, v68 dst_sel:DWORD dst_unused:UNUSED_PAD src0_sel:DWORD src1_sel:WORD_1
    v_lshlrev_b32_sdwa v138, 3, v69 dst_sel:DWORD dst_unused:UNUSED_PAD src0_sel:DWORD src1_sel:WORD_0
    v_lshlrev_b32_sdwa v139, 3, v69 dst_sel:DWORD dst_unused:UNUSED_PAD src0_sel:DWORD src1_sel:WORD_1
    v_lshlrev_b32_sdwa v140, 3, v70 dst_sel:DWORD dst_unused:UNUSED_PAD src0_sel:DWORD src1_sel:WORD_0
    v_lshlrev_b32_sdwa v141, 3, v70 dst_sel:DWORD dst_unused:UNUSED_PAD src0_sel:DWORD src1_sel:WORD_1
    v_lshlrev_b32_sdwa v142, 3, v71 dst_sel:DWORD dst_unused:UNUSED_PAD src0_sel:DWORD src1_sel:WORD_0
    v_lshlrev_b32_sdwa v143, 3, v71 dst_sel:DWORD dst_unused:UNUSED_PAD src0_sel:DWORD src1_sel:WORD_1
    s_waitcnt vmcnt(9)
    v_lshlrev_b32_sdwa v144, 3, v72 dst_sel:DWORD dst_unused:UNUSED_PAD src0_sel:DWORD src1_sel:WORD_0
    v_lshlrev_b32_sdwa v145, 3, v72 dst_sel:DWORD dst_unused:UNUSED_PAD src0_sel:DWORD src1_sel:WORD_1
    v_lshlrev_b32_sdwa v146, 3, v73 dst_sel:DWORD dst_unused:UNUSED_PAD src0_sel:DWORD src1_sel:WORD_0
    v_lshlrev_b32_sdwa v147, 3, v73 dst_sel:DWORD dst_unused:UNUSED_PAD src0_sel:DWORD src1_sel:WORD_1
    v_lshlrev_b32_sdwa v148, 3, v74 dst_sel:DWORD dst_unused:UNUSED_PAD src0_sel:DWORD src1_sel:WORD_0
    v_lshlrev_b32_sdwa v149, 3, v74 dst_sel:DWORD dst_unused:UNUSED_PAD src0_sel:DWORD src1_sel:WORD_1
    v_lshlrev_b32_sdwa v150, 3, v75 dst_sel:DWORD dst_unused:UNUSED_PAD src0_sel:DWORD src1_sel:WORD_0
    v_lshlrev_b32_sdwa v151, 3, v75 dst_sel:DWORD dst_unused:UNUSED_PAD src0_sel:DWORD src1_sel:WORD_1
    s_waitcnt vmcnt(8)
    v_lshlrev_b32_sdwa v152, 3, v76 dst_sel:DWORD dst_unused:UNUSED_PAD src0_sel:DWORD src1_sel:WORD_0
    v_lshlrev_b32_sdwa v153, 3, v76 dst_sel:DWORD dst_unused:UNUSED_PAD src0_sel:DWORD src1_sel:WORD_1
    v_lshlrev_b32_sdwa v154, 3, v77 dst_sel:DWORD dst_unused:UNUSED_PAD src0_sel:DWORD src1_sel:WORD_0
    v_lshlrev_b32_sdwa v155, 3, v77 dst_sel:DWORD dst_unused:UNUSED_PAD src0_sel:DWORD src1_sel:WORD_1
    s_waitcnt vmcnt(7)
    v_lshlrev_b32_sdwa v156, 3, v84 dst_sel:DWORD dst_unused:UNUSED_PAD src0_sel:DWORD src1_sel:WORD_0
    v_lshlrev_b32_sdwa v157, 3, v84 dst_sel:DWORD dst_unused:UNUSED_PAD src0_sel:DWORD src1_sel:WORD_1
    v_lshlrev_b32_sdwa v158, 3, v85 dst_sel:DWORD dst_unused:UNUSED_PAD src0_sel:DWORD src1_sel:WORD_0
    v_lshlrev_b32_sdwa v159, 3, v85 dst_sel:DWORD dst_unused:UNUSED_PAD src0_sel:DWORD src1_sel:WORD_1
    v_lshlrev_b32_sdwa v160, 3, v86 dst_sel:DWORD dst_unused:UNUSED_PAD src0_sel:DWORD src1_sel:WORD_0
    v_lshlrev_b32_sdwa v161, 3, v86 dst_sel:DWORD dst_unused:UNUSED_PAD src0_sel:DWORD src1_sel:WORD_1
    v_lshlrev_b32_sdwa v162, 3, v87 dst_sel:DWORD dst_unused:UNUSED_PAD src0_sel:DWORD src1_sel:WORD_0
    v_lshlrev_b32_sdwa v163, 3, v87 dst_sel:DWORD dst_unused:UNUSED_PAD src0_sel:DWORD src1_sel:WORD_1
    s_waitcnt vmcnt(6)
    v_lshlrev_b32_sdwa v164, 3, v88 dst_sel:DWORD dst_unused:UNUSED_PAD src0_sel:DWORD src1_sel:WORD_0
    v_lshlrev_b32_sdwa v165, 3, v88 dst_sel:DWORD dst_unused:UNUSED_PAD src0_sel:DWORD src1_sel:WORD_1
    v_lshlrev_b32_sdwa v166, 3, v89 dst_sel:DWORD dst_unused:UNUSED_PAD src0_sel:DWORD src1_sel:WORD_0
    v_lshlrev_b32_sdwa v167, 3, v89 dst_sel:DWORD dst_unused:UNUSED_PAD src0_sel:DWORD src1_sel:WORD_1
    v_lshlrev_b32_sdwa v168, 3, v90 dst_sel:DWORD dst_unused:UNUSED_PAD src0_sel:DWORD src1_sel:WORD_0
    v_lshlrev_b32_sdwa v169, 3, v90 dst_sel:DWORD dst_unused:UNUSED_PAD src0_sel:DWORD src1_sel:WORD_1
    v_lshlrev_b32_sdwa v170, 3, v91 dst_sel:DWORD dst_unused:UNUSED_PAD src0_sel:DWORD src1_sel:WORD_0
    v_lshlrev_b32_sdwa v171, 3, v91 dst_sel:DWORD dst_unused:UNUSED_PAD src0_sel:DWORD src1_sel:WORD_1
    s_waitcnt vmcnt(5)
    v_lshlrev_b32_sdwa v172, 3, v92 dst_sel:DWORD dst_unused:UNUSED_PAD src0_sel:DWORD src1_sel:WORD_0
    v_lshlrev_b32_sdwa v173, 3, v92 dst_sel:DWORD dst_unused:UNUSED_PAD src0_sel:DWORD src1_sel:WORD_1
    v_lshlrev_b32_sdwa v174, 3, v93 dst_sel:DWORD dst_unused:UNUSED_PAD src0_sel:DWORD src1_sel:WORD_0
    v_lshlrev_b32_sdwa v175, 3, v93 dst_sel:DWORD dst_unused:UNUSED_PAD src0_sel:DWORD src1_sel:WORD_1
    v_lshlrev_b32_sdwa v176, 3, v94 dst_sel:DWORD dst_unused:UNUSED_PAD src0_sel:DWORD src1_sel:WORD_0
    v_lshlrev_b32_sdwa v177, 3, v94 dst_sel:DWORD dst_unused:UNUSED_PAD src0_sel:DWORD src1_sel:WORD_1
    v_lshlrev_b32_sdwa v178, 3, v95 dst_sel:DWORD dst_unused:UNUSED_PAD src0_sel:DWORD src1_sel:WORD_0
    v_lshlrev_b32_sdwa v179, 3, v95 dst_sel:DWORD dst_unused:UNUSED_PAD src0_sel:DWORD src1_sel:WORD_1
    s_waitcnt vmcnt(4)
    v_lshlrev_b32_sdwa v180, 3, v96 dst_sel:DWORD dst_unused:UNUSED_PAD src0_sel:DWORD src1_sel:WORD_0
    v_lshlrev_b32_sdwa v181, 3, v96 dst_sel:DWORD dst_unused:UNUSED_PAD src0_sel:DWORD src1_sel:WORD_1
    v_lshlrev_b32_sdwa v182, 3, v97 dst_sel:DWORD dst_unused:UNUSED_PAD src0_sel:DWORD src1_sel:WORD_0
    v_lshlrev_b32_sdwa v183, 3, v97 dst_sel:DWORD dst_unused:UNUSED_PAD src0_sel:DWORD src1_sel:WORD_1
    s_waitcnt vmcnt(3)
    v_lshlrev_b32_sdwa v184, 3, v104 dst_sel:DWORD dst_unused:UNUSED_PAD src0_sel:DWORD src1_sel:WORD_0
    v_lshlrev_b32_sdwa v185, 3, v104 dst_sel:DWORD dst_unused:UNUSED_PAD src0_sel:DWORD src1_sel:WORD_1
    v_lshlrev_b32_sdwa v186, 3, v105 dst_sel:DWORD dst_unused:UNUSED_PAD src0_sel:DWORD src1_sel:WORD_0
    v_lshlrev_b32_sdwa v187, 3, v105 dst_sel:DWORD dst_unused:UNUSED_PAD src0_sel:DWORD src1_sel:WORD_1
    v_lshlrev_b32_sdwa v188, 3, v106 dst_sel:DWORD dst_unused:UNUSED_PAD src0_sel:DWORD src1_sel:WORD_0
    v_lshlrev_b32_sdwa v189, 3, v106 dst_sel:DWORD dst_unused:UNUSED_PAD src0_sel:DWORD src1_sel:WORD_1
    v_lshlrev_b32_sdwa v190, 3, v107 dst_sel:DWORD dst_unused:UNUSED_PAD src0_sel:DWORD src1_sel:WORD_0
    v_lshlrev_b32_sdwa v191, 3, v107 dst_sel:DWORD dst_unused:UNUSED_PAD src0_sel:DWORD src1_sel:WORD_1
    s_waitcnt vmcnt(2)
    v_lshlrev_b32_sdwa v192, 3, v108 dst_sel:DWORD dst_unused:UNUSED_PAD src0_sel:DWORD src1_sel:WORD_0
    v_lshlrev_b32_sdwa v193, 3, v108 dst_sel:DWORD dst_unused:UNUSED_PAD src0_sel:DWORD src1_sel:WORD_1
    v_lshlrev_b32_sdwa v194, 3, v109 dst_sel:DWORD dst_unused:UNUSED_PAD src0_sel:DWORD src1_sel:WORD_0
    v_lshlrev_b32_sdwa v195, 3, v109 dst_sel:DWORD dst_unused:UNUSED_PAD src0_sel:DWORD src1_sel:WORD_1
    v_lshlrev_b32_sdwa v196, 3, v110 dst_sel:DWORD dst_unused:UNUSED_PAD src0_sel:DWORD src1_sel:WORD_0
    v_lshlrev_b32_sdwa v197, 3, v110 dst_sel:DWORD dst_unused:UNUSED_PAD src0_sel:DWORD src1_sel:WORD_1
    v_lshlrev_b32_sdwa v198, 3, v111 dst_sel:DWORD dst_unused:UNUSED_PAD src0_sel:DWORD src1_sel:WORD_0
    v_lshlrev_b32_sdwa v199, 3, v111 dst_sel:DWORD dst_unused:UNUSED_PAD src0_sel:DWORD src1_sel:WORD_1
    s_waitcnt vmcnt(1)
    v_lshlrev_b32_sdwa v200, 3, v112 dst_sel:DWORD dst_unused:UNUSED_PAD src0_sel:DWORD src1_sel:WORD_0
    v_lshlrev_b32_sdwa v201, 3, v112 dst_sel:DWORD dst_unused:UNUSED_PAD src0_sel:DWORD src1_sel:WORD_1
    v_lshlrev_b32_sdwa v202, 3, v113 dst_sel:DWORD dst_unused:UNUSED_PAD src0_sel:DWORD src1_sel:WORD_0
    v_lshlrev_b32_sdwa v203, 3, v113 dst_sel:DWORD dst_unused:UNUSED_PAD src0_sel:DWORD src1_sel:WORD_1
    v_lshlrev_b32_sdwa v204, 3, v114 dst_sel:DWORD dst_unused:UNUSED_PAD src0_sel:DWORD src1_sel:WORD_0
    v_lshlrev_b32_sdwa v205, 3, v114 dst_sel:DWORD dst_unused:UNUSED_PAD src0_sel:DWORD src1_sel:WORD_1
    v_lshlrev_b32_sdwa v206, 3, v115 dst_sel:DWORD dst_unused:UNUSED_PAD src0_sel:DWORD src1_sel:WORD_0
    v_lshlrev_b32_sdwa v207, 3, v115 dst_sel:DWORD dst_unused:UNUSED_PAD src0_sel:DWORD src1_sel:WORD_1
    s_waitcnt vmcnt(0)
    v_lshlrev_b32_sdwa v208, 3, v116 dst_sel:DWORD dst_unused:UNUSED_PAD src0_sel:DWORD src1_sel:WORD_0
    v_lshlrev_b32_sdwa v209, 3, v116 dst_sel:DWORD dst_unused:UNUSED_PAD src0_sel:DWORD src1_sel:WORD_1
    v_lshlrev_b32_sdwa v210, 3, v117 dst_sel:DWORD dst_unused:UNUSED_PAD src0_sel:DWORD src1_sel:WORD_0
    v_lshlrev_b32_sdwa v211, 3, v117 dst_sel:DWORD dst_unused:UNUSED_PAD src0_sel:DWORD src1_sel:WORD_1
    s_branch KI_NX
KI_E2:
    s_waitcnt vmcnt(7)
    v_lshlrev_b32_sdwa v128, 3, v64 dst_sel:DWORD dst_unused:UNUSED_PAD src0_sel:DWORD src1_sel:WORD_0
    v_lshlrev_b32_sdwa v129, 3, v64 dst_sel:DWORD dst_unused:UNUSED_PAD src0_sel:DWORD src1_sel:WORD_1
    v_lshlrev_b32_sdwa v130, 3, v65 dst_sel:DWORD dst_unused:UNUSED_PAD src0_sel:DWORD src1_sel:WORD_0
    v_lshlrev_b32_sdwa v131, 3, v65 dst_sel:DWORD dst_unused:UNUSED_PAD src0_sel:DWORD src1_sel:WORD_1
    v_lshlrev_b32_sdwa v132, 3, v66 dst_sel:DWORD dst_unused:UNUSED_PAD src0_sel:DWORD src1_sel:WORD_0
    v_lshlrev_b32_sdwa v133, 3, v66 dst_sel:DWORD dst_unused:UNUSED_PAD src0_sel:DWORD src1_sel:WORD_1
    v_lshlrev_b32_sdwa v134, 3, v67 dst_sel:DWORD dst_unused:UNUSED_PAD src0_sel:DWORD src1_sel:WORD_0
    v_lshlrev_b32_sdwa v135, 3, v67 dst_sel:DWORD dst_unused:UNUSED_PAD src0_sel:DWORD src1_sel:WORD_1
    s_waitcnt vmcnt(6)
    v_lshlrev_b32_sdwa v136, 3, v68 dst_sel:DWORD dst_unused:UNUSED_PAD src0_sel:DWORD src1_sel:WORD_0
    v_lshlrev_b32_sdwa v137, 3, v68 dst_sel:DWORD dst_unused:UNUSED_PAD src0_sel:DWORD src1_sel:WORD_1
    v_lshlrev_b32_sdwa v138, 3, v69 dst_sel:DWORD dst_unused:UNUSED_PAD src0_sel:DWORD src1_sel:WORD_0
    v_lshlrev_b32_sdwa v139, 3, v69 dst_sel:DWORD dst_unused:UNUSED_PAD src0_sel:DWORD src1_sel:WORD_1
    v_lshlrev_b32_sdwa v140, 3, v70 dst_sel:DWORD dst_unused:UNUSED_PAD src0_sel:DWORD src1_sel:WORD_0
    v_lshlrev_b32_sdwa v141, 3, v70 dst_sel:DWORD dst_unused:UNUSED_PAD src0_sel:DWORD src1_sel:WORD_1
    v_lshlrev_b32_sdwa v142, 3, v71 dst_sel:DWORD dst_unused:UNUSED_PAD src0_sel:DWORD src1_sel:WORD_0
    v_lshlrev_b32_sdwa v143, 3, v71 dst_sel:DWORD dst_unused:UNUSED_PAD src0_sel:DWORD src1_sel:WORD_1
    s_waitcnt vmcnt(5)
    v_lshlrev_b32_sdwa v144, 3, v72 dst_sel:DWORD dst_unused:UNUSED_PAD src0_sel:DWORD src1_sel:WORD_0
    v_lshlrev_b32_sdwa v145, 3, v72 dst_sel:DWORD dst_unused:UNUSED_PAD src0_sel:DWORD src1_sel:WORD_1
    v_lshlrev_b32_sdwa v146, 3, v73 dst_sel:DWORD dst_unused:UNUSED_PAD src0_sel:DWORD src1_sel:WORD_0
    v_lshlrev_b32_sdwa v147, 3, v73 dst_sel:DWORD dst_unused:UNUSED_PAD src0_sel:DWORD src1_sel:WORD_1
    v_lshlrev_b32_sdwa v148, 3, v74 dst_sel:DWORD dst_unused:UNUSED_PAD src0_sel:DWORD src1_sel:WORD_0
    v_lshlrev_b32_sdwa v149, 3, v74 dst_sel:DWORD dst_unused:UNUSED_PAD src0_sel:DWORD src1_sel:WORD_1
    v_lshlrev_b32_sdwa v150, 3, v75 dst_sel:DWORD dst_unused:UNUSED_PAD src0_sel:DWORD src1_sel:WORD_0
    v_lshlrev_b32_sdwa v151, 3, v75 dst_sel:DWORD dst_unused:UNUSED_PAD src0_sel:DWORD src1_sel:WORD_1
    s_waitcnt vmcnt(4)
    v_lshlrev_b32_sdwa v152, 3, v76 dst_sel:DWORD dst_unused:UNUSED_PAD src0_sel:DWORD src1_sel:WORD_0
    v_lshlrev_b32_sdwa v153, 3, v76 dst_sel:DWORD dst_unused:UNUSED_PAD src0_sel:DWORD src1_sel:WORD_1
    v_lshlrev_b32_sdwa v154, 3, v77 dst_sel:DWORD dst_unused:UNUSED_PAD src0_sel:DWORD src1_sel:WORD_0
    v_lshlrev_b32_sdwa v155, 3, v77 dst_sel:DWORD dst_unused:UNUSED_PAD src0_sel:DWORD src1_sel:WORD_1
    s_waitcnt vmcnt(3)
    v_lshlrev_b32_sdwa v156, 3, v84 dst_sel:DWORD dst_unused:UNUSED_PAD src0_sel:DWORD src1_sel:WORD_0
    v_lshlrev_b32_sdwa v157, 3, v84 dst_sel:DWORD dst_unused:UNUSED_PAD src0_sel:DWORD src1_sel:WORD_1
    v_lshlrev_b32_sdwa v158, 3, v85 dst_sel:DWORD dst_unused:UNUSED_PAD src0_sel:DWORD src1_sel:WORD_0
    v_lshlrev_b32_sdwa v159, 3, v85 dst_sel:DWORD dst_unused:UNUSED_PAD src0_sel:DWORD src1_sel:WORD_1
    v_lshlrev_b32_sdwa v160, 3, v86 dst_sel:DWORD dst_unused:UNUSED_PAD src0_sel:DWORD src1_sel:WORD_0
    v_lshlrev_b32_sdwa v161, 3, v86 dst_sel:DWORD dst_unused:UNUSED_PAD src0_sel:DWORD src1_sel:WORD_1
    v_lshlrev_b32_sdwa v162, 3, v87 dst_sel:DWORD dst_unused:UNUSED_PAD src0_sel:DWORD src1_sel:WORD_0
    v_lshlrev_b32_sdwa v163, 3, v87 dst_sel:DWORD dst_unused:UNUSED_PAD src0_sel:DWORD src1_sel:WORD_1
    s_waitcnt vmcnt(2)
    v_lshlrev_b32_sdwa v164, 3, v88 dst_sel:DWORD dst_unused:UNUSED_PAD src0_sel:DWORD src1_sel:WORD_0
    v_lshlrev_b32_sdwa v165, 3, v88 dst_sel:DWORD dst_unused:UNUSED_PAD src0_sel:DWORD src1_sel:WORD_1
    v_lshlrev_b32_sdwa v166, 3, v89 dst_sel:DWORD dst_unused:UNUSED_PAD src0_sel:DWORD src1_sel:WORD_0
    v_lshlrev_b32_sdwa v167, 3, v89 dst_sel:DWORD dst_unused:UNUSED_PAD src0_sel:DWORD src1_sel:WORD_1
    v_lshlrev_b32_sdwa v168, 3, v90 dst_sel:DWORD dst_unused:UNUSED_PAD src0_sel:DWORD src1_sel:WORD_0
    v_lshlrev_b32_sdwa v169, 3, v90 dst_sel:DWORD dst_unused:UNUSED_PAD src0_sel:DWORD src1_sel:WORD_1
    v_lshlrev_b32_sdwa v170, 3, v91 dst_sel:DWORD dst_unused:UNUSED_PAD src0_sel:DWORD src1_sel:WORD_0
    v_lshlrev_b32_sdwa v171, 3, v91 dst_sel:DWORD dst_unused:UNUSED_PAD src0_sel:DWORD src1_sel:WORD_1
    s_waitcnt vmcnt(1)
    v_lshlrev_b32_sdwa v172, 3, v92 dst_sel:DWORD dst_unused:UNUSED_PAD src0_sel:DWORD src1_sel:WORD_0
    v_lshlrev_b32_sdwa v173, 3, v92 dst_sel:DWORD dst_unused:UNUSED_PAD src0_sel:DWORD src1_sel:WORD_1
    v_lshlrev_b32_sdwa v174, 3, v93 dst_sel:DWORD dst_unused:UNUSED_PAD src0_sel:DWORD src1_sel:WORD_0
    v_lshlrev_b32_sdwa v175, 3, v93 dst_sel:DWORD dst_unused:UNUSED_PAD src0_sel:DWORD src1_sel:WORD_1
    v_lshlrev_b32_sdwa v176, 3, v94 dst_sel:DWORD dst_unused:UNUSED_PAD src0_sel:DWORD src1_sel:WORD_0
    v_lshlrev_b32_sdwa v177, 3, v94 dst_sel:DWORD dst_unused:UNUSED_PAD src0_sel:DWORD src1_sel:WORD_1
    v_lshlrev_b32_sdwa v178, 3, v95 dst_sel:DWORD dst_unused:UNUSED_PAD src0_sel:DWORD src1_sel:WORD_0
    v_lshlrev_b32_sdwa v179, 3, v95 dst_sel:DWORD dst_unused:UNUSED_PAD src0_sel:DWORD src1_sel:WORD_1
    s_waitcnt vmcnt(0)
    v_lshlrev_b32_sdwa v180, 3, v96 dst_sel:DWORD dst_unused:UNUSED_PAD src0_sel:DWORD src1_sel:WORD_0
    v_lshlrev_b32_sdwa v181, 3, v96 dst_sel:DWORD dst_unused:UNUSED_PAD src0_sel:DWORD src1_sel:WORD_1
    v_lshlrev_b32_sdwa v182, 3, v97 dst_sel:DWORD dst_unused:UNUSED_PAD src0_sel:DWORD src1_sel:WORD_0
    v_lshlrev_b32_sdwa v183, 3, v97 dst_sel:DWORD dst_unused:UNUSED_PAD src0_sel:DWORD src1_sel:WORD_1
KI_NX:
    s_cmp_lt_u32 s36, 4
    s_cbranch_scc1 KI_NP
    s_setprio 1
KI_NP:
    s_mov_b32 s77, 17920000
KH:
    ds_read_b64 v[224:225], v128
    ds_read_b64 v[226:227], v129
    ds_read_b64 v[228:229], v130
    ds_read_b64 v[230:231], v131
    ds_read_b64 v[232:233], v132
    ds_read_b64 v[234:235], v133
    ds_read_b64 v[236:237], v134
    ds_read_b64 v[238:239], v135
    s_cmp_lg_u32 s64, 0
    s_cbranch_scc1 KH_SPEC
KH_MAIN:
    s_cmp_eq_u32 s41, 7
    s_cbranch_scc1 KH_M7
    s_cmp_eq_u32 s39, 0
    s_cbranch_scc1 KH_MG
    ds_read_b64 v[240:241], v136
    ds_read_b64 v[242:243], v137
    ds_read_b64 v[244:245], v138
    ds_read_b64 v[246:247], v139
    s_waitcnt lgkmcnt(8)
    v_smfmac_f32_16x16x64_bf16 v[20:23], v[16:19], v[224:231], v63
    buffer_store_dwordx2 v[32:33], v248, s[20:23], s76 offen sc1
    ds_read_b64 v[224:225], v140
    ds_read_b64 v[226:227], v141
    ds_read_b64 v[228:229], v142
    ds_read_b64 v[230:231], v143
    s_waitcnt lgkmcnt(8)
    v_smfmac_f32_16x16x64_bf16 v[20:23], v[16:19], v[232:239], v63
    ds_read_b64 v[232:233], v144
    ds_read_b64 v[234:235], v145
    ds_read_b64 v[236:237], v146
    ds_read_b64 v[238:239], v147
    s_waitcnt lgkmcnt(8)
    v_smfmac_f32_16x16x64_bf16 v[20:23], v[16:19], v[240:247], v63
    buffer_store_dwordx2 v[34:35], v249, s[20:23], s76 offen sc1
    ds_read_b64 v[240:241], v148
    ds_read_b64 v[242:243], v149
    ds_read_b64 v[244:245], v150
    ds_read_b64 v[246:247], v151
    s_waitcnt lgkmcnt(8)
    v_smfmac_f32_16x16x64_bf16 v[20:23], v[16:19], v[224:231], v63
    ds_read_b64 v[224:225], v152
    ds_read_b64 v[226:227], v153
    ds_read_b64 v[228:229], v154
    ds_read_b64 v[230:231], v155
    s_waitcnt lgkmcnt(8)
    v_smfmac_f32_16x16x64_bf16 v[20:23], v[16:19], v[232:239], v63
    buffer_store_dwordx2 v[36:37], v250, s[20:23], s76 offen sc1
    ds_read_b64 v[232:233], v156
    ds_read_b64 v[234:235], v157
    ds_read_b64 v[236:237], v158
    ds_read_b64 v[238:239], v159
    s_waitcnt lgkmcnt(8)
    v_smfmac_f32_16x16x64_bf16 v[20:23], v[16:19], v[240:247], v63
    ds_read_b64 v[240:241], v160
    ds_read_b64 v[242:243], v161
    ds_read_b64 v[244:245], v162
    ds_read_b64 v[246:247], v163
    s_waitcnt lgkmcnt(8)
    v_smfmac_f32_16x16x64_bf16 v[20:23], v[16:19], v[224:231], v63
    ds_read_b64 v[224:225], v164
    ds_read_b64 v[226:227], v165
    ds_read_b64 v[228:229], v166
    ds_read_b64 v[230:231], v167
    s_waitcnt lgkmcnt(8)
    v_smfmac_f32_16x16x64_bf16 v[24:27], v[16:19], v[232:239], v63
    ds_read_b64 v[232:233], v168
    ds_read_b64 v[234:235], v169
    ds_read_b64 v[236:237], v170
    ds_read_b64 v[238:239], v171
    s_waitcnt lgkmcnt(8)
    v_smfmac_f32_16x16x64_bf16 v[24:27], v[16:19], v[240:247], v63
    v_mul_f32 v4, v20, v11
    v_mul_f32 v5, v21, v11
    v_mul_f32 v6, v22, v11
    v_mul_f32 v7, v23, v11
    v_cvt_pk_bf16_f32 v216, v4, v5
    v_cvt_pk_bf16_f32 v217, v6, v7
    buffer_store_dwordx2 v[216:217], v212, s[16:19], 0 offen
    ds_read_b64 v[240:241], v172
    ds_read_b64 v[242:243], v173
    ds_read_b64 v[244:245], v174
    ds_read_b64 v[246:247], v175
    s_waitcnt lgkmcnt(8)
    v_smfmac_f32_16x16x64_bf16 v[24:27], v[16:19], v[224:231], v63
    s_cmp_eq_u32 s79, 0
    s_cbranch_scc1 KH_NCKL
    s_mov_b32 s79, 0
    s_waitcnt vmcnt(4)
    v_cmp_eq_u32 vcc, s46, v60
    v_cmp_eq_u32 s[62:63], s47, v61
    s_nop 0
    s_and_b64 vcc, vcc, s[62:63]
    s_cmp_eq_u32 vcc_lo, -1
    s_cbranch_scc0 KH_NCKL
    s_mul_i32 s49, s58, 2560000
    s_add_u32 s49, s49, s95
    s_mul_i32 s50, s58, 2064
    s_add_u32 s50, s50, 80000
    s_cmp_eq_u32 s58, 7
    s_cmov_b32 s50, 240
    s_add_u32 m0, s50, s96
    s_add_u32 s58, s58, 1
    buffer_load_dwordx4 v2, s[20:23], s49 offen sc1 lds
    buffer_load_dwordx4 v2, s[20:23], s49 offen offset:1024 sc1 lds
    s_cmp_lg_u32 s36, 4
    s_cbranch_scc1 KTD7
    s_add_u32 m0, s50, 57792
    s_add_u32 s49, s49, 8192
    buffer_load_dwordx4 v2, s[20:23], s49 offen sc1 lds
    buffer_load_dwordx4 v2, s[20:23], s49 offen offset:1024 sc1 lds
KTD7:
KH_NCKL:
    ds_read_b64 v[224:225], v176
    ds_read_b64 v[226:227], v177
    ds_read_b64 v[228:229], v178
    ds_read_b64 v[230:231], v179
    s_waitcnt lgkmcnt(8)
    v_smfmac_f32_16x16x64_bf16 v[24:27], v[16:19], v[232:239], v63
    ds_read_b64 v[232:233], v180
    ds_read_b64 v[234:235], v181
    ds_read_b64 v[236:237], v182
    ds_read_b64 v[238:239], v183
    s_waitcnt lgkmcnt(8)
    v_smfmac_f32_16x16x64_bf16 v[24:27], v[16:19], v[240:247], v63
    s_cmp_eq_u32 s44, 0
    s_cbranch_scc1 KH_TWOL
    ds_read_b64 v[240:241], v184
    ds_read_b64 v[242:243], v185
    ds_read_b64 v[244:245], v186
    ds_read_b64 v[246:247], v187
    s_waitcnt lgkmcnt(8)
    v_smfmac_f32_16x16x64_bf16 v[24:27], v[16:19], v[224:231], v63
    ds_read_b64 v[224:225], v188
    ds_read_b64 v[226:227], v189
    ds_read_b64 v[228:229], v190
    ds_read_b64 v[230:231], v191
    s_waitcnt lgkmcnt(8)
    v_smfmac_f32_16x16x64_bf16 v[24:27], v[16:19], v[232:239], v63
    ds_read_b64 v[232:233], v192
    ds_read_b64 v[234:235], v193
    ds_read_b64 v[236:237], v194
    ds_read_b64 v[238:239], v195
    s_waitcnt lgkmcnt(8)
    v_smfmac_f32_16x16x64_bf16 v[28:31], v[16:19], v[240:247], v63
    ds_read_b64 v[240:241], v196
    ds_read_b64 v[242:243], v197
    ds_read_b64 v[244:245], v198
    ds_read_b64 v[246:247], v199
    s_waitcnt lgkmcnt(8)
    v_smfmac_f32_16x16x64_bf16 v[28:31], v[16:19], v[224:231], v63
    v_mul_f32 v4, v24, v12
    v_mul_f32 v5, v25, v12
    v_mul_f32 v6, v26, v12
    v_mul_f32 v7, v27, v12
    v_cvt_pk_bf16_f32 v218, v4, v5
    v_cvt_pk_bf16_f32 v219, v6, v7
    buffer_store_dwordx2 v[218:219], v213, s[16:19], 0 offen
    ds_read_b64 v[224:225], v200
    ds_read_b64 v[226:227], v201
    ds_read_b64 v[228:229], v202
    ds_read_b64 v[230:231], v203
    s_waitcnt lgkmcnt(8)
    v_smfmac_f32_16x16x64_bf16 v[28:31], v[16:19], v[232:239], v63
    ds_read_b64 v[232:233], v204
    ds_read_b64 v[234:235], v205
    ds_read_b64 v[236:237], v206
    ds_read_b64 v[238:239], v207
    s_waitcnt lgkmcnt(8)
    v_smfmac_f32_16x16x64_bf16 v[28:31], v[16:19], v[240:247], v63
    ds_read_b64 v[240:241], v208
    ds_read_b64 v[242:243], v209
    ds_read_b64 v[244:245], v210
    ds_read_b64 v[246:247], v211
    s_waitcnt lgkmcnt(8)
    v_smfmac_f32_16x16x64_bf16 v[28:31], v[16:19], v[224:231], v63
    s_waitcnt lgkmcnt(4)
    v_smfmac_f32_16x16x64_bf16 v[28:31], v[16:19], v[232:239], v63
    s_waitcnt lgkmcnt(0)
    v_smfmac_f32_16x16x64_bf16 v[28:31], v[16:19], v[240:247], v63
    s_nop 11
    v_mul_f32 v4, v28, v13
    v_mul_f32 v5, v29, v13
    v_mul_f32 v6, v30, v13
    v_mul_f32 v7, v31, v13
    v_cvt_pk_bf16_f32 v220, v4, v5
    v_cvt_pk_bf16_f32 v221, v6, v7
    buffer_store_dwordx2 v[220:221], v214, s[16:19], 0 offen
    s_branch KH_GD
KH_TWOL:
    s_waitcnt lgkmcnt(4)
    v_smfmac_f32_16x16x64_bf16 v[24:27], v[16:19], v[224:231], v63
    s_waitcnt lgkmcnt(0)
    v_smfmac_f32_16x16x64_bf16 v[24:27], v[16:19], v[232:239], v63
    s_nop 11
    v_mul_f32 v4, v24, v12
    v_mul_f32 v5, v25, v12
    v_mul_f32 v6, v26, v12
    v_mul_f32 v7, v27, v12
    v_cvt_pk_bf16_f32 v218, v4, v5
    v_cvt_pk_bf16_f32 v219, v6, v7
    buffer_store_dwordx2 v[218:219], v213, s[16:19], 0 offen
    s_branch KH_GD
KH_M7:
    ds_read_b64 v[240:241], v136
    ds_read_b64 v[242:243], v137
    ds_read_b64 v[244:245], v138
    ds_read_b64 v[246:247], v139
    s_waitcnt lgkmcnt(8)
    v_smfmac_f32_16x16x64_bf16 v[20:23], v[16:19], v[224:231], v63
    buffer_store_dwordx2 v[32:33], v248, s[20:23], s76 offen sc1
    ds_read_b64 v[224:225], v140
    ds_read_b64 v[226:227], v141
    ds_read_b64 v[228:229], v142
    ds_read_b64 v[230:231], v143
    s_waitcnt lgkmcnt(8)
    v_smfmac_f32_16x16x64_bf16 v[20:23], v[16:19], v[232:239], v63
    ds_read_b64 v[232:233], v144
    ds_read_b64 v[234:235], v145
    ds_read_b64 v[236:237], v146
    ds_read_b64 v[238:239], v147
    s_waitcnt lgkmcnt(8)
    v_smfmac_f32_16x16x64_bf16 v[20:23], v[16:19], v[240:247], v63
    buffer_store_dwordx2 v[34:35], v249, s[20:23], s76 offen sc1
    ds_read_b64 v[240:241], v148
    ds_read_b64 v[242:243], v149
    ds_read_b64 v[244:245], v150
    ds_read_b64 v[246:247], v151
    s_waitcnt lgkmcnt(8)
    v_smfmac_f32_16x16x64_bf16 v[20:23], v[16:19], v[224:231], v63
    ds_read_b64 v[224:225], v152
    ds_read_b64 v[226:227], v153
    ds_read_b64 v[228:229], v154
    ds_read_b64 v[230:231], v155
    s_waitcnt lgkmcnt(8)
    v_smfmac_f32_16x16x64_bf16 v[20:23], v[16:19], v[232:239], v63
    buffer_store_dwordx2 v[36:37], v250, s[20:23], s76 offen sc1
    ds_read_b64 v[232:233], v156
    ds_read_b64 v[234:235], v157
    ds_read_b64 v[236:237], v158
    ds_read_b64 v[238:239], v159
    s_waitcnt lgkmcnt(8)
    v_smfmac_f32_16x16x64_bf16 v[20:23], v[16:19], v[240:247], v63
    ds_read_b64 v[240:241], v160
    ds_read_b64 v[242:243], v161
    ds_read_b64 v[244:245], v162
    ds_read_b64 v[246:247], v163
    s_waitcnt lgkmcnt(8)
    v_smfmac_f32_16x16x64_bf16 v[20:23], v[16:19], v[224:231], v63
    ds_read_b64 v[224:225], v164
    ds_read_b64 v[226:227], v165
    ds_read_b64 v[228:229], v166
    ds_read_b64 v[230:231], v167
    s_waitcnt lgkmcnt(8)
    v_smfmac_f32_16x16x64_bf16 v[24:27], v[16:19], v[232:239], v63
    ds_read_b64 v[232:233], v168
    ds_read_b64 v[234:235], v169
    ds_read_b64 v[236:237], v170
    ds_read_b64 v[238:239], v171
    s_waitcnt lgkmcnt(8)
    v_smfmac_f32_16x16x64_bf16 v[24:27], v[16:19], v[240:247], v63
    v_mul_f32 v4, v20, v8
    v_mul_f32 v5, v21, v8
    v_mul_f32 v6, v22, v8
    v_mul_f32 v7, v23, v8
    v_cvt_pk_bf16_f32 v216, v4, v5
    v_cvt_pk_bf16_f32 v217, v6, v7
    buffer_store_dwordx2 v[216:217], v248, s[20:23], s77 offen sc1
    ds_read_b64 v[240:241], v172
    ds_read_b64 v[242:243], v173
    ds_read_b64 v[244:245], v174
    ds_read_b64 v[246:247], v175
    s_waitcnt lgkmcnt(8)
    v_smfmac_f32_16x16x64_bf16 v[24:27], v[16:19], v[224:231], v63
    s_cmp_eq_u32 s79, 0
    s_cbranch_scc1 KH_NCK7
    s_mov_b32 s79, 0
    s_waitcnt vmcnt(4)
    v_cmp_eq_u32 vcc, s46, v60
    v_cmp_eq_u32 s[62:63], s47, v61
    s_nop 0
    s_and_b64 vcc, vcc, s[62:63]
    s_cmp_eq_u32 vcc_lo, -1
    s_cbranch_scc0 KH_NCK7
    s_mul_i32 s49, s58, 2560000
    s_add_u32 s49, s49, s95
    s_mul_i32 s50, s58, 2064
    s_add_u32 s50, s50, 80000
    s_cmp_eq_u32 s58, 7
    s_cmov_b32 s50, 240
    s_add_u32 m0, s50, s96
    s_add_u32 s58, s58, 1
    buffer_load_dwordx4 v2, s[20:23], s49 offen sc1 lds
    buffer_load_dwordx4 v2, s[20:23], s49 offen offset:1024 sc1 lds
    s_cmp_lg_u32 s36, 4
    s_cbranch_scc1 KTD8
    s_add_u32 m0, s50, 57792
    s_add_u32 s49, s49, 8192
    buffer_load_dwordx4 v2, s[20:23], s49 offen sc1 lds
    buffer_load_dwordx4 v2, s[20:23], s49 offen offset:1024 sc1 lds
KTD8:
KH_NCK7:
    ds_read_b64 v[224:225], v176
    ds_read_b64 v[226:227], v177
    ds_read_b64 v[228:229], v178
    ds_read_b64 v[230:231], v179
    s_waitcnt lgkmcnt(8)
    v_smfmac_f32_16x16x64_bf16 v[24:27], v[16:19], v[232:239], v63
    ds_read_b64 v[232:233], v180
    ds_read_b64 v[234:235], v181
    ds_read_b64 v[236:237], v182
    ds_read_b64 v[238:239], v183
    s_waitcnt lgkmcnt(8)
    v_smfmac_f32_16x16x64_bf16 v[24:27], v[16:19], v[240:247], v63
    s_cmp_eq_u32 s44, 0
    s_cbranch_scc1 KH_TWO7
    ds_read_b64 v[240:241], v184
    ds_read_b64 v[242:243], v185
    ds_read_b64 v[244:245], v186
    ds_read_b64 v[246:247], v187
    s_waitcnt lgkmcnt(8)
    v_smfmac_f32_16x16x64_bf16 v[24:27], v[16:19], v[224:231], v63
    ds_read_b64 v[224:225], v188
    ds_read_b64 v[226:227], v189
    ds_read_b64 v[228:229], v190
    ds_read_b64 v[230:231], v191
    s_waitcnt lgkmcnt(8)
    v_smfmac_f32_16x16x64_bf16 v[24:27], v[16:19], v[232:239], v63
    ds_read_b64 v[232:233], v192
    ds_read_b64 v[234:235], v193
    ds_read_b64 v[236:237], v194
    ds_read_b64 v[238:239], v195
    s_waitcnt lgkmcnt(8)
    v_smfmac_f32_16x16x64_bf16 v[28:31], v[16:19], v[240:247], v63
    ds_read_b64 v[240:241], v196
    ds_read_b64 v[242:243], v197
    ds_read_b64 v[244:245], v198
    ds_read_b64 v[246:247], v199
    s_waitcnt lgkmcnt(8)
    v_smfmac_f32_16x16x64_bf16 v[28:31], v[16:19], v[224:231], v63
    v_mul_f32 v4, v24, v9
    v_mul_f32 v5, v25, v9
    v_mul_f32 v6, v26, v9
    v_mul_f32 v7, v27, v9
    v_cvt_pk_bf16_f32 v218, v4, v5
    v_cvt_pk_bf16_f32 v219, v6, v7
    buffer_store_dwordx2 v[218:219], v249, s[20:23], s77 offen sc1
    ds_read_b64 v[224:225], v200
    ds_read_b64 v[226:227], v201
    ds_read_b64 v[228:229], v202
    ds_read_b64 v[230:231], v203
    s_waitcnt lgkmcnt(8)
    v_smfmac_f32_16x16x64_bf16 v[28:31], v[16:19], v[232:239], v63
    ds_read_b64 v[232:233], v204
    ds_read_b64 v[234:235], v205
    ds_read_b64 v[236:237], v206
    ds_read_b64 v[238:239], v207
    s_waitcnt lgkmcnt(8)
    v_smfmac_f32_16x16x64_bf16 v[28:31], v[16:19], v[240:247], v63
    ds_read_b64 v[240:241], v208
    ds_read_b64 v[242:243], v209
    ds_read_b64 v[244:245], v210
    ds_read_b64 v[246:247], v211
    s_waitcnt lgkmcnt(8)
    v_smfmac_f32_16x16x64_bf16 v[28:31], v[16:19], v[224:231], v63
    s_waitcnt lgkmcnt(4)
    v_smfmac_f32_16x16x64_bf16 v[28:31], v[16:19], v[232:239], v63
    s_waitcnt lgkmcnt(0)
    v_smfmac_f32_16x16x64_bf16 v[28:31], v[16:19], v[240:247], v63
    s_nop 11
    v_mul_f32 v4, v28, v10
    v_mul_f32 v5, v29, v10
    v_mul_f32 v6, v30, v10
    v_mul_f32 v7, v31, v10
    v_cvt_pk_bf16_f32 v220, v4, v5
    v_cvt_pk_bf16_f32 v221, v6, v7
    buffer_store_dwordx2 v[220:221], v250, s[20:23], s77 offen sc1
    s_branch KH_GD
KH_TWO7:
    s_waitcnt lgkmcnt(4)
    v_smfmac_f32_16x16x64_bf16 v[24:27], v[16:19], v[224:231], v63
    s_waitcnt lgkmcnt(0)
    v_smfmac_f32_16x16x64_bf16 v[24:27], v[16:19], v[232:239], v63
    s_nop 11
    v_mul_f32 v4, v24, v9
    v_mul_f32 v5, v25, v9
    v_mul_f32 v6, v26, v9
    v_mul_f32 v7, v27, v9
    v_cvt_pk_bf16_f32 v218, v4, v5
    v_cvt_pk_bf16_f32 v219, v6, v7
    buffer_store_dwordx2 v[218:219], v249, s[20:23], s77 offen sc1
    s_branch KH_GD
KH_MG:
    ds_read_b64 v[240:241], v136
    ds_read_b64 v[242:243], v137
    ds_read_b64 v[244:245], v138
    ds_read_b64 v[246:247], v139
    s_waitcnt lgkmcnt(8)
    v_smfmac_f32_16x16x64_bf16 v[20:23], v[16:19], v[224:231], v63
    buffer_store_dwordx2 v[32:33], v248, s[20:23], s76 offen sc1
    ds_read_b64 v[224:225], v140
    ds_read_b64 v[226:227], v141
    ds_read_b64 v[228:229], v142
    ds_read_b64 v[230:231], v143
    s_waitcnt lgkmcnt(8)
    v_smfmac_f32_16x16x64_bf16 v[20:23], v[16:19], v[232:239], v63
    ds_read_b64 v[232:233], v144
    ds_read_b64 v[234:235], v145
    ds_read_b64 v[236:237], v146
    ds_read_b64 v[238:239], v147
    s_waitcnt lgkmcnt(8)
    v_smfmac_f32_16x16x64_bf16 v[20:23], v[16:19], v[240:247], v63
    buffer_store_dwordx2 v[34:35], v249, s[20:23], s76 offen sc1
    ds_read_b64 v[240:241], v148
    ds_read_b64 v[242:243], v149
    ds_read_b64 v[244:245], v150
    ds_read_b64 v[246:247], v151
    s_waitcnt lgkmcnt(8)
    v_smfmac_f32_16x16x64_bf16 v[20:23], v[16:19], v[224:231], v63
    ds_read_b64 v[224:225], v152
    ds_read_b64 v[226:227], v153
    ds_read_b64 v[228:229], v154
    ds_read_b64 v[230:231], v155
    s_waitcnt lgkmcnt(8)
    v_smfmac_f32_16x16x64_bf16 v[20:23], v[16:19], v[232:239], v63
    buffer_store_dwordx2 v[36:37], v250, s[20:23], s76 offen sc1
    ds_read_b64 v[232:233], v156
    ds_read_b64 v[234:235], v157
    ds_read_b64 v[236:237], v158
    ds_read_b64 v[238:239], v159
    s_waitcnt lgkmcnt(8)
    v_smfmac_f32_16x16x64_bf16 v[20:23], v[16:19], v[240:247], v63
    ds_read_b64 v[240:241], v160
    ds_read_b64 v[242:243], v161
    ds_read_b64 v[244:245], v162
    ds_read_b64 v[246:247], v163
    s_waitcnt lgkmcnt(8)
    v_smfmac_f32_16x16x64_bf16 v[20:23], v[16:19], v[224:231], v63
    ds_read_b64 v[224:225], v164
    ds_read_b64 v[226:227], v165
    ds_read_b64 v[228:229], v166
    ds_read_b64 v[230:231], v167
    s_waitcnt lgkmcnt(8)
    v_smfmac_f32_16x16x64_bf16 v[24:27], v[16:19], v[232:239], v63
    ds_read_b64 v[232:233], v168
    ds_read_b64 v[234:235], v169
    ds_read_b64 v[236:237], v170
    ds_read_b64 v[238:239], v171
    s_waitcnt lgkmcnt(8)
    v_smfmac_f32_16x16x64_bf16 v[24:27], v[16:19], v[240:247], v63
    v_mul_f32 v4, v20, v11
    v_mul_f32 v5, v21, v11
    v_mul_f32 v6, v22, v11
    v_mul_f32 v7, v23, v11
    v_cvt_pk_bf16_f32 v216, v4, v5
    v_cvt_pk_bf16_f32 v217, v6, v7
    buffer_store_dwordx2 v[216:217], v212, s[16:19], 0 offen sc1
    ds_read_b64 v[240:241], v172
    ds_read_b64 v[242:243], v173
    ds_read_b64 v[244:245], v174
    ds_read_b64 v[246:247], v175
    s_waitcnt lgkmcnt(8)
    v_smfmac_f32_16x16x64_bf16 v[24:27], v[16:19], v[224:231], v63
    s_cmp_eq_u32 s79, 0
    s_cbranch_scc1 KH_NCKG
    s_mov_b32 s79, 0
    s_waitcnt vmcnt(4)
    v_cmp_eq_u32 vcc, s46, v60
    v_cmp_eq_u32 s[62:63], s47, v61
    s_nop 0
    s_and_b64 vcc, vcc, s[62:63]
    s_cmp_eq_u32 vcc_lo, -1
    s_cbranch_scc0 KH_NCKG
    s_mul_i32 s49, s58, 2560000
    s_add_u32 s49, s49, s95
    s_mul_i32 s50, s58, 2064
    s_add_u32 s50, s50, 80000
    s_cmp_eq_u32 s58, 7
    s_cmov_b32 s50, 240
    s_add_u32 m0, s50, s96
    s_add_u32 s58, s58, 1
    buffer_load_dwordx4 v2, s[20:23], s49 offen sc1 lds
    buffer_load_dwordx4 v2, s[20:23], s49 offen offset:1024 sc1 lds
    s_cmp_lg_u32 s36, 4
    s_cbranch_scc1 KTD9
    s_add_u32 m0, s50, 57792
    s_add_u32 s49, s49, 8192
    buffer_load_dwordx4 v2, s[20:23], s49 offen sc1 lds
    buffer_load_dwordx4 v2, s[20:23], s49 offen offset:1024 sc1 lds
KTD9:
KH_NCKG:
    ds_read_b64 v[224:225], v176
    ds_read_b64 v[226:227], v177
    ds_read_b64 v[228:229], v178
    ds_read_b64 v[230:231], v179
    s_waitcnt lgkmcnt(8)
    v_smfmac_f32_16x16x64_bf16 v[24:27], v[16:19], v[232:239], v63
    ds_read_b64 v[232:233], v180
    ds_read_b64 v[234:235], v181
    ds_read_b64 v[236:237], v182
    ds_read_b64 v[238:239], v183
    s_waitcnt lgkmcnt(8)
    v_smfmac_f32_16x16x64_bf16 v[24:27], v[16:19], v[240:247], v63
    s_cmp_eq_u32 s44, 0
    s_cbranch_scc1 KH_TWOG
    ds_read_b64 v[240:241], v184
    ds_read_b64 v[242:243], v185
    ds_read_b64 v[244:245], v186
    ds_read_b64 v[246:247], v187
    s_waitcnt lgkmcnt(8)
    v_smfmac_f32_16x16x64_bf16 v[24:27], v[16:19], v[224:231], v63
    ds_read_b64 v[224:225], v188
    ds_read_b64 v[226:227], v189
    ds_read_b64 v[228:229], v190
    ds_read_b64 v[230:231], v191
    s_waitcnt lgkmcnt(8)
    v_smfmac_f32_16x16x64_bf16 v[24:27], v[16:19], v[232:239], v63
    ds_read_b64 v[232:233], v192
    ds_read_b64 v[234:235], v193
    ds_read_b64 v[236:237], v194
    ds_read_b64 v[238:239], v195
    s_waitcnt lgkmcnt(8)
    v_smfmac_f32_16x16x64_bf16 v[28:31], v[16:19], v[240:247], v63
    ds_read_b64 v[240:241], v196
    ds_read_b64 v[242:243], v197
    ds_read_b64 v[244:245], v198
    ds_read_b64 v[246:247], v199
    s_waitcnt lgkmcnt(8)
    v_smfmac_f32_16x16x64_bf16 v[28:31], v[16:19], v[224:231], v63
    v_mul_f32 v4, v24, v12
    v_mul_f32 v5, v25, v12
    v_mul_f32 v6, v26, v12
    v_mul_f32 v7, v27, v12
    v_cvt_pk_bf16_f32 v218, v4, v5
    v_cvt_pk_bf16_f32 v219, v6, v7
    buffer_store_dwordx2 v[218:219], v213, s[16:19], 0 offen sc1
    ds_read_b64 v[224:225], v200
    ds_read_b64 v[226:227], v201
    ds_read_b64 v[228:229], v202
    ds_read_b64 v[230:231], v203
    s_waitcnt lgkmcnt(8)
    v_smfmac_f32_16x16x64_bf16 v[28:31], v[16:19], v[232:239], v63
    ds_read_b64 v[232:233], v204
    ds_read_b64 v[234:235], v205
    ds_read_b64 v[236:237], v206
    ds_read_b64 v[238:239], v207
    s_waitcnt lgkmcnt(8)
    v_smfmac_f32_16x16x64_bf16 v[28:31], v[16:19], v[240:247], v63
    ds_read_b64 v[240:241], v208
    ds_read_b64 v[242:243], v209
    ds_read_b64 v[244:245], v210
    ds_read_b64 v[246:247], v211
    s_waitcnt lgkmcnt(8)
    v_smfmac_f32_16x16x64_bf16 v[28:31], v[16:19], v[224:231], v63
    s_waitcnt lgkmcnt(4)
    v_smfmac_f32_16x16x64_bf16 v[28:31], v[16:19], v[232:239], v63
    s_waitcnt lgkmcnt(0)
    v_smfmac_f32_16x16x64_bf16 v[28:31], v[16:19], v[240:247], v63
    s_nop 11
    v_mul_f32 v4, v28, v13
    v_mul_f32 v5, v29, v13
    v_mul_f32 v6, v30, v13
    v_mul_f32 v7, v31, v13
    v_cvt_pk_bf16_f32 v220, v4, v5
    v_cvt_pk_bf16_f32 v221, v6, v7
    buffer_store_dwordx2 v[220:221], v214, s[16:19], 0 offen sc1
    s_branch KH_GD
KH_TWOG:
    s_waitcnt lgkmcnt(4)
    v_smfmac_f32_16x16x64_bf16 v[24:27], v[16:19], v[224:231], v63
    s_waitcnt lgkmcnt(0)
    v_smfmac_f32_16x16x64_bf16 v[24:27], v[16:19], v[232:239], v63
    s_nop 11
    v_mul_f32 v4, v24, v12
    v_mul_f32 v5, v25, v12
    v_mul_f32 v6, v26, v12
    v_mul_f32 v7, v27, v12
    v_cvt_pk_bf16_f32 v218, v4, v5
    v_cvt_pk_bf16_f32 v219, v6, v7
    buffer_store_dwordx2 v[218:219], v213, s[16:19], 0 offen sc1
KH_GD:
    s_mov_b32 s12, s16
    s_mov_b32 s13, s17
    s_add_u32 s52, s46, s41
    v_mov_b32 v4, s52
    v_mov_b32 v5, s47
    v_mov_b32 v3, 0
    s_waitcnt vmcnt(0)
    s_cmp_eq_u32 s41, 7
    s_cbranch_scc1 KT
    s_mov_b64 exec, 1
    s_cmp_eq_u32 s39, 0
    s_cbranch_scc1 KH_HFS_G
    buffer_store_dwordx2 v[4:5], v3, s[8:11], s54 offen
    s_branch KH_HFS_J
KH_HFS_G:
    buffer_store_dwordx2 v[4:5], v3, s[8:11], s54 offen sc1
KH_HFS_J:
    s_mov_b64 exec, -1
    s_barrier
    ds_write_b64 v212, v[216:217]
    ds_write_b64 v213, v[218:219]
    ds_write_b64 v214, v[220:221]
    s_cmp_eq_u32 s36, s38
    s_cbranch_scc1 KH_OWN
    s_mov_b64 exec, 0xff
KH_HP_L:
    buffer_load_dwordx2 v[38:39], v222, s[8:11], s55 offen sc1
    s_sub_u32 s65, s65, 1
    s_cbranch_scc1 KH_HP_T
    s_waitcnt vmcnt(0)
    v_sub_u32 v38, v38, v4
    v_xor_b32 v39, v39, v5
    v_cmp_lt_u32 vcc, 7, v38
    v_cmp_ne_u32 s[62:63], 0, v39
    s_nop 0
    s_or_b64 vcc, vcc, s[62:63]
    s_cbranch_vccnz KH_HP_L
    s_branch KH_HP_D
KH_HP_T:
    s_mov_b32 s65, 0
    s_mov_b32 s40, 1
    s_waitcnt vmcnt(0)
KH_HP_D:
    s_mov_b64 exec, -1
    s_add_u32 s49, s53, 4096
    s_add_u32 s50, s53, 8192
    s_mov_b32 m0, s53
    s_nop 0
    buffer_load_dwordx4 v2, s[12:15], s53 offen offset:0 sc1 lds
    buffer_load_dwordx4 v2, s[12:15], s53 offen offset:1024 sc1 lds
    buffer_load_dwordx4 v2, s[12:15], s53 offen offset:2048 sc1 lds
    buffer_load_dwordx4 v2, s[12:15], s53 offen offset:3072 sc1 lds
    s_mov_b32 m0, s49
    s_nop 0
    buffer_load_dwordx4 v2, s[12:15], s49 offen offset:0 sc1 lds
    buffer_load_dwordx4 v2, s[12:15], s49 offen offset:1024 sc1 lds
    buffer_load_dwordx4 v2, s[12:15], s49 offen offset:2048 sc1 lds
    buffer_load_dwordx4 v2, s[12:15], s49 offen offset:3072 sc1 lds
    s_mov_b32 m0, s50
    s_cmp_eq_u32 s36, 7
    s_cbranch_scc1 KH_F_7
    buffer_load_dwordx4 v2, s[12:15], s50 offen sc1 lds
    buffer_load_dwordx4 v2, s[12:15], s50 offen offset:1024 sc1 lds
    s_branch KH_F_E
KH_F_7:
    s_mov_b64 exec, 0xff
    buffer_load_dwordx4 v2, s[12:15], s50 offen sc1 lds
    s_mov_b64 exec, -1
KH_F_E:
KH_OWN:
    v_mul_f32 v4, v20, v8
    v_mul_f32 v5, v21, v8
    v_mul_f32 v6, v22, v8
    v_mul_f32 v7, v23, v8
    v_cvt_pk_bf16_f32 v32, v4, v5
    v_cvt_pk_bf16_f32 v33, v6, v7
    v_mul_f32 v4, v24, v9
    v_mul_f32 v5, v25, v9
    v_mul_f32 v6, v26, v9
    v_mul_f32 v7, v27, v9
    v_cvt_pk_bf16_f32 v34, v4, v5
    v_cvt_pk_bf16_f32 v35, v6, v7
    v_mul_f32 v4, v28, v10
    v_mul_f32 v5, v29, v10
    v_mul_f32 v6, v30, v10
    v_mul_f32 v7, v31, v10
    v_cvt_pk_bf16_f32 v36, v4, v5
    v_cvt_pk_bf16_f32 v37, v6, v7
    v_mov_b32 v20, 0
    v_mov_b32 v21, 0
    v_mov_b32 v22, 0
    v_mov_b32 v23, 0
    v_mov_b32 v24, 0
    v_mov_b32 v25, 0
    v_mov_b32 v26, 0
    v_mov_b32 v27, 0
    v_mov_b32 v28, 0
    v_mov_b32 v29, 0
    v_mov_b32 v30, 0
    v_mov_b32 v31, 0
    s_mul_i32 s76, s41, 2560000
    s_add_u32 s41, s41, 1
    s_and_b32 s49, s41, 1
    s_add_u32 s50, s41, 2
    s_cmp_eq_u32 s39, 0
    s_cmov_b32 s49, s50
    s_mul_i32 s49, s49, 2621440
    s_add_u32 s49, s49, s57
    s_add_u32 s16, s4, s49
    s_addc_u32 s17, s5, 0
    v_mov_b32 v4, s46
    v_mov_b32 v5, s47
    v_mov_b32 v61, 0
    s_waitcnt vmcnt(0) lgkmcnt(0)
    s_cmp_lt_u32 s36, 4
    s_cbranch_scc1 KH_NOT
    s_cmp_lg_u32 s36, 7
    s_cbranch_scc1 KH_NHF
    s_cmp_lt_u32 s41, 3
    s_cbranch_scc1 KH_NHF
    s_mov_b64 exec, 1
    buffer_store_dwordx2 v[4:5], v3, s[8:11], s98 offen sc1
    s_mov_b64 exec, -1
    s_add_u32 s98, s98, 16384
KH_NHF:
    s_cmp_lg_u32 s36, 6
    s_cbranch_scc1 KH_NWP
    s_cmp_lg_u32 s41, 3
    s_cbranch_scc1 KH_NWP
    s_mov_b32 s49, 38912
    s_cmp_lg_u32 s40, 0
    s_cbranch_scc1 KH_WP_X
    s_add_u32 s97, s46, 0
    s_mov_b32 s52, 0
    s_mov_b64 exec, 3
KH_WP_L:
    buffer_load_dwordx2 v[38:39], v62, s[8:11], s49 offen sc1
    s_waitcnt vmcnt(0)
    v_subrev_u32 v38, s97, v38
    v_cmp_gt_u32 vcc, 64, v38
    v_cmp_eq_u32 s[62:63], s47, v39
    s_nop 0
    s_and_b64 vcc, vcc, s[62:63]
    s_cmp_eq_u64 vcc, exec
    s_cbranch_scc1 KH_WP_D
    s_add_u32 s52, s52, 1
    s_cmp_lt_u32 s52, 1048576
    s_cbranch_scc1 KH_WP_L
    s_mov_b32 s40, 1
KH_WP_D:
    s_mov_b64 exec, -1
KH_WP_X:
KH_NWP:
    s_cmp_lg_u32 s36, 5
    s_cbranch_scc1 KH_NWW
    s_cmp_lg_u32 s41, 5
    s_cbranch_scc1 KH_NWW
    s_lshr_b32 s49, s2, 3
    s_mul_i32 s49, s49, 2176
    s_add_u32 s49, s49, 190464
    s_mov_b64 exec, 0x1ffff
    v_lshlrev_b32 v3, 1, v62
    buffer_load_dword v124, v3, s[8:11], s49 offen
    s_mov_b64 exec, -1
KH_NWW:
    s_add_u32 s49, s58, 3
    s_cmp_gt_u32 s49, s41
    s_cbranch_scc1 KH_NOT
    s_cmp_lg_u32 s45, 0
    s_cbranch_scc1 KH_NOT
    s_mul_i32 s49, s58, 16384
    s_add_u32 s49, s49, s94
    s_mov_b32 exec_hi, 0
    buffer_load_dwordx2 v[60:61], v62, s[8:11], s49 offen sc1
    s_mov_b64 exec, -1
    s_mov_b32 s79, 1
KH_NOT:
    s_barrier
    s_branch KH
KH_SPEC:
    s_cmp_eq_u32 s64, 2
    s_cbranch_scc1 KH_SLOW
    s_cmp_le_u32 s42, 28
    s_cbranch_scc1 KX0
    v_lshlrev_b32_sdwa v40, 3, v78 dst_sel:DWORD dst_unused:UNUSED_PAD src0_sel:DWORD src1_sel:WORD_0
    v_lshlrev_b32_sdwa v41, 3, v78 dst_sel:DWORD dst_unused:UNUSED_PAD src0_sel:DWORD src1_sel:WORD_1
    v_lshlrev_b32_sdwa v42, 3, v79 dst_sel:DWORD dst_unused:UNUSED_PAD src0_sel:DWORD src1_sel:WORD_0
    v_lshlrev_b32_sdwa v43, 3, v79 dst_sel:DWORD dst_unused:UNUSED_PAD src0_sel:DWORD src1_sel:WORD_1
    ds_read_b64 v[240:241], v40
    ds_read_b64 v[242:243], v41
    ds_read_b64 v[244:245], v42
    ds_read_b64 v[246:247], v43
    s_waitcnt lgkmcnt(0)
    v_smfmac_f32_16x16x64_bf16 v[20:23], v[16:19], v[240:247], v63
    s_cmp_le_u32 s42, 32
    s_cbranch_scc1 KX0
    v_lshlrev_b32_sdwa v40, 3, v80 dst_sel:DWORD dst_unused:UNUSED_PAD src0_sel:DWORD src1_sel:WORD_0
    v_lshlrev_b32_sdwa v41, 3, v80 dst_sel:DWORD dst_unused:UNUSED_PAD src0_sel:DWORD src1_sel:WORD_1
    v_lshlrev_b32_sdwa v42, 3, v81 dst_sel:DWORD dst_unused:UNUSED_PAD src0_sel:DWORD src1_sel:WORD_0
    v_lshlrev_b32_sdwa v43, 3, v81 dst_sel:DWORD dst_unused:UNUSED_PAD src0_sel:DWORD src1_sel:WORD_1
    ds_read_b64 v[240:241], v40
    ds_read_b64 v[242:243], v41
    ds_read_b64 v[244:245], v42
    ds_read_b64 v[246:247], v43
    s_waitcnt lgkmcnt(0)
    v_smfmac_f32_16x16x64_bf16 v[20:23], v[16:19], v[240:247], v63
    s_cmp_le_u32 s42, 36
    s_cbranch_scc1 KX0
    v_lshlrev_b32_sdwa v40, 3, v82 dst_sel:DWORD dst_unused:UNUSED_PAD src0_sel:DWORD src1_sel:WORD_0
    v_lshlrev_b32_sdwa v41, 3, v82 dst_sel:DWORD dst_unused:UNUSED_PAD src0_sel:DWORD src1_sel:WORD_1
    v_lshlrev_b32_sdwa v42, 3, v83 dst_sel:DWORD dst_unused:UNUSED_PAD src0_sel:DWORD src1_sel:WORD_0
    v_lshlrev_b32_sdwa v43, 3, v83 dst_sel:DWORD dst_unused:UNUSED_PAD src0_sel:DWORD src1_sel:WORD_1
    ds_read_b64 v[240:241], v40
    ds_read_b64 v[242:243], v41
    ds_read_b64 v[244:245], v42
    ds_read_b64 v[246:247], v43
    s_waitcnt lgkmcnt(0)
    v_smfmac_f32_16x16x64_bf16 v[20:23], v[16:19], v[240:247], v63
KX0:
    s_cmp_le_u32 s43, 28
    s_cbranch_scc1 KX1
    v_lshlrev_b32_sdwa v40, 3, v98 dst_sel:DWORD dst_unused:UNUSED_PAD src0_sel:DWORD src1_sel:WORD_0
    v_lshlrev_b32_sdwa v41, 3, v98 dst_sel:DWORD dst_unused:UNUSED_PAD src0_sel:DWORD src1_sel:WORD_1
    v_lshlrev_b32_sdwa v42, 3, v99 dst_sel:DWORD dst_unused:UNUSED_PAD src0_sel:DWORD src1_sel:WORD_0
    v_lshlrev_b32_sdwa v43, 3, v99 dst_sel:DWORD dst_unused:UNUSED_PAD src0_sel:DWORD src1_sel:WORD_1
    ds_read_b64 v[240:241], v40
    ds_read_b64 v[242:243], v41
    ds_read_b64 v[244:245], v42
    ds_read_b64 v[246:247], v43
    s_waitcnt lgkmcnt(0)
    v_smfmac_f32_16x16x64_bf16 v[24:27], v[16:19], v[240:247], v63
    s_cmp_le_u32 s43, 32
    s_cbranch_scc1 KX1
    v_lshlrev_b32_sdwa v40, 3, v100 dst_sel:DWORD dst_unused:UNUSED_PAD src0_sel:DWORD src1_sel:WORD_0
    v_lshlrev_b32_sdwa v41, 3, v100 dst_sel:DWORD dst_unused:UNUSED_PAD src0_sel:DWORD src1_sel:WORD_1
    v_lshlrev_b32_sdwa v42, 3, v101 dst_sel:DWORD dst_unused:UNUSED_PAD src0_sel:DWORD src1_sel:WORD_0
    v_lshlrev_b32_sdwa v43, 3, v101 dst_sel:DWORD dst_unused:UNUSED_PAD src0_sel:DWORD src1_sel:WORD_1
    ds_read_b64 v[240:241], v40
    ds_read_b64 v[242:243], v41
    ds_read_b64 v[244:245], v42
    ds_read_b64 v[246:247], v43
    s_waitcnt lgkmcnt(0)
    v_smfmac_f32_16x16x64_bf16 v[24:27], v[16:19], v[240:247], v63
    s_cmp_le_u32 s43, 36
    s_cbranch_scc1 KX1
    v_lshlrev_b32_sdwa v40, 3, v102 dst_sel:DWORD dst_unused:UNUSED_PAD src0_sel:DWORD src1_sel:WORD_0
    v_lshlrev_b32_sdwa v41, 3, v102 dst_sel:DWORD dst_unused:UNUSED_PAD src0_sel:DWORD src1_sel:WORD_1
    v_lshlrev_b32_sdwa v42, 3, v103 dst_sel:DWORD dst_unused:UNUSED_PAD src0_sel:DWORD src1_sel:WORD_0
    v_lshlrev_b32_sdwa v43, 3, v103 dst_sel:DWORD dst_unused:UNUSED_PAD src0_sel:DWORD src1_sel:WORD_1
    ds_read_b64 v[240:241], v40
    ds_read_b64 v[242:243], v41
    ds_read_b64 v[244:245], v42
    ds_read_b64 v[246:247], v43
    s_waitcnt lgkmcnt(0)
    v_smfmac_f32_16x16x64_bf16 v[24:27], v[16:19], v[240:247], v63
KX1:
    s_cmp_le_u32 s44, 28
    s_cbranch_scc1 KX2
    v_lshlrev_b32_sdwa v40, 3, v118 dst_sel:DWORD dst_unused:UNUSED_PAD src0_sel:DWORD src1_sel:WORD_0
    v_lshlrev_b32_sdwa v41, 3, v118 dst_sel:DWORD dst_unused:UNUSED_PAD src0_sel:DWORD src1_sel:WORD_1
    v_lshlrev_b32_sdwa v42, 3, v119 dst_sel:DWORD dst_unused:UNUSED_PAD src0_sel:DWORD src1_sel:WORD_0
    v_lshlrev_b32_sdwa v43, 3, v119 dst_sel:DWORD dst_unused:UNUSED_PAD src0_sel:DWORD src1_sel:WORD_1
    ds_read_b64 v[240:241], v40
    ds_read_b64 v[242:243], v41
    ds_read_b64 v[244:245], v42
    ds_read_b64 v[246:247], v43
    s_waitcnt lgkmcnt(0)
    v_smfmac_f32_16x16x64_bf16 v[28:31], v[16:19], v[240:247], v63
    s_cmp_le_u32 s44, 32
    s_cbranch_scc1 KX2
    v_lshlrev_b32_sdwa v40, 3, v120 dst_sel:DWORD dst_unused:UNUSED_PAD src0_sel:DWORD src1_sel:WORD_0
    v_lshlrev_b32_sdwa v41, 3, v120 dst_sel:DWORD dst_unused:UNUSED_PAD src0_sel:DWORD src1_sel:WORD_1
    v_lshlrev_b32_sdwa v42, 3, v121 dst_sel:DWORD dst_unused:UNUSED_PAD src0_sel:DWORD src1_sel:WORD_0
    v_lshlrev_b32_sdwa v43, 3, v121 dst_sel:DWORD dst_unused:UNUSED_PAD src0_sel:DWORD src1_sel:WORD_1
    ds_read_b64 v[240:241], v40
    ds_read_b64 v[242:243], v41
    ds_read_b64 v[244:245], v42
    ds_read_b64 v[246:247], v43
    s_waitcnt lgkmcnt(0)
    v_smfmac_f32_16x16x64_bf16 v[28:31], v[16:19], v[240:247], v63
    s_cmp_le_u32 s44, 36
    s_cbranch_scc1 KX2
    v_lshlrev_b32_sdwa v40, 3, v122 dst_sel:DWORD dst_unused:UNUSED_PAD src0_sel:DWORD src1_sel:WORD_0
    v_lshlrev_b32_sdwa v41, 3, v122 dst_sel:DWORD dst_unused:UNUSED_PAD src0_sel:DWORD src1_sel:WORD_1
    v_lshlrev_b32_sdwa v42, 3, v123 dst_sel:DWORD dst_unused:UNUSED_PAD src0_sel:DWORD src1_sel:WORD_0
    v_lshlrev_b32_sdwa v43, 3, v123 dst_sel:DWORD dst_unused:UNUSED_PAD src0_sel:DWORD src1_sel:WORD_1
    ds_read_b64 v[240:241], v40
    ds_read_b64 v[242:243], v41
    ds_read_b64 v[244:245], v42
    ds_read_b64 v[246:247], v43
    s_waitcnt lgkmcnt(0)
    v_smfmac_f32_16x16x64_bf16 v[28:31], v[16:19], v[240:247], v63
KX2:
    s_branch KH_MAIN
KH_SLOW:
    s_waitcnt lgkmcnt(0)
    s_load_dwordx4 s[84:87], s[0:1], 8
    buffer_store_dwordx2 v[32:33], v248, s[20:23], s76 offen sc1
    buffer_store_dwordx2 v[34:35], v249, s[20:23], s76 offen sc1
    buffer_store_dwordx2 v[36:37], v250, s[20:23], s76 offen sc1
    v_lshlrev_b32 v6, 4, v0
    v_add_u32 v6, 80000, v6
    v_mov_b32 v224, 0
    v_mov_b32 v225, 0
    v_mov_b32 v226, 0
    v_mov_b32 v227, 0
    ds_write_b128 v6, v[224:227] offset:0
    ds_write_b128 v6, v[224:227] offset:8192
    ds_write_b128 v6, v[224:227] offset:16384
    s_mul_i32 s51, s38, 1280
    v_lshlrev_b32 v7, 2, v0
    s_mov_b32 s52, 0
    s_waitcnt lgkmcnt(0)
    s_mov_b32 s28, s84
    s_mov_b32 s29, s85
    s_mov_b32 s30, 0x0009c400
    s_mov_b32 s31, 0x20000
    s_mov_b32 s32, s86
    s_mov_b32 s33, s87
    s_mov_b32 s34, 0x0009c400
    s_mov_b32 s35, 0x20000
    s_barrier
KS_L:
    buffer_load_dword v224, v7, s[32:35], s52 offen
    buffer_load_dword v225, v7, s[28:31], s52 offen
    v_add_u32 v3, s52, v7
    v_cmp_gt_u32 s[60:61], s30, v3
    s_waitcnt vmcnt(0)
    v_subrev_u32 v224, s51, v224
    v_cmp_gt_u32 vcc, 1280, v224
    s_nop 0
    s_and_b64 exec, vcc, s[60:61]
    v_lshlrev_b32 v225, 3, v225
    ds_read_b64 v[226:227], v225
    v_lshlrev_b32 v224, 4, v224
    v_add_u32 v224, 80000, v224
    s_waitcnt lgkmcnt(0)
    v_lshlrev_b32 v228, 16, v226
    v_and_b32 v229, 0xffff0000, v226
    v_lshlrev_b32 v230, 16, v227
    v_and_b32 v231, 0xffff0000, v227
    ds_add_f32 v224, v228 offset:0
    ds_add_f32 v224, v229 offset:4
    ds_add_f32 v224, v230 offset:8
    ds_add_f32 v224, v231 offset:12
    s_mov_b64 exec, -1
    s_add_u32 s52, s52, 2048
    s_cmp_lt_u32 s52, 640000
    s_cbranch_scc1 KS_L
    s_waitcnt lgkmcnt(0)
    s_barrier
    ds_read_b128 v[20:23], v6 offset:0
    ds_read_b128 v[24:27], v6 offset:8192
    ds_read_b128 v[28:31], v6 offset:16384
    s_waitcnt lgkmcnt(0)
    s_cmp_eq_u32 s41, 7
    s_cbranch_scc1 KS_E7
    v_mul_f32 v4, v20, v11
    v_mul_f32 v5, v21, v11
    v_mul_f32 v6, v22, v11
    v_mul_f32 v7, v23, v11
    v_cvt_pk_bf16_f32 v216, v4, v5
    v_cvt_pk_bf16_f32 v217, v6, v7
    buffer_store_dwordx2 v[216:217], v212, s[16:19], 0 offen sc1
    v_mul_f32 v4, v24, v12
    v_mul_f32 v5, v25, v12
    v_mul_f32 v6, v26, v12
    v_mul_f32 v7, v27, v12
    v_cvt_pk_bf16_f32 v218, v4, v5
    v_cvt_pk_bf16_f32 v219, v6, v7
    buffer_store_dwordx2 v[218:219], v213, s[16:19], 0 offen sc1
    v_mul_f32 v4, v28, v13
    v_mul_f32 v5, v29, v13
    v_mul_f32 v6, v30, v13
    v_mul_f32 v7, v31, v13
    v_cvt_pk_bf16_f32 v220, v4, v5
    v_cvt_pk_bf16_f32 v221, v6, v7
    buffer_store_dwordx2 v[220:221], v214, s[16:19], 0 offen sc1
    s_branch KH_GD
KS_E7:
    v_mul_f32 v4, v20, v8
    v_mul_f32 v5, v21, v8
    v_mul_f32 v6, v22, v8
    v_mul_f32 v7, v23, v8
    v_cvt_pk_bf16_f32 v216, v4, v5
    v_cvt_pk_bf16_f32 v217, v6, v7
    buffer_store_dwordx2 v[216:217], v248, s[20:23], s77 offen sc1
    v_mul_f32 v4, v24, v9
    v_mul_f32 v5, v25, v9
    v_mul_f32 v6, v26, v9
    v_mul_f32 v7, v27, v9
    v_cvt_pk_bf16_f32 v218, v4, v5
    v_cvt_pk_bf16_f32 v219, v6, v7
    buffer_store_dwordx2 v[218:219], v249, s[20:23], s77 offen sc1
    v_mul_f32 v4, v28, v10
    v_mul_f32 v5, v29, v10
    v_mul_f32 v6, v30, v10
    v_mul_f32 v7, v31, v10
    v_cvt_pk_bf16_f32 v220, v4, v5
    v_cvt_pk_bf16_f32 v221, v6, v7
    buffer_store_dwordx2 v[220:221], v250, s[20:23], s77 offen sc1
    s_branch KH_GD
KT:
    s_barrier
    s_cmp_lg_u32 s36, 7
    s_cbranch_scc1 KT_NF
    v_mov_b32 v4, s46
    s_add_u32 s98, s98, 16384
    s_mov_b64 exec, 1
    buffer_store_dwordx2 v[4:5], v3, s[8:11], s98 offen sc1
    s_mov_b64 exec, -1
KT_NF:
    s_cmp_ge_u32 s2, 250
    s_cbranch_scc1 K_FIN
    s_lshl_b32 s66, s36, 3
    s_lshl_b32 s67, s36, 13
    s_add_u32 s67, s67, 190464
    s_mul_i32 s49, s66, 43
    s_lshr_b32 s49, s49, 9
    s_min_u32 s49, s49, 4
    s_mul_i32 s49, s49, 2160
    s_lshl_b32 s65, s66, 10
    s_add_u32 s49, s49, s65
    s_add_u32 m0, s49, 2304
    s_add_u32 s66, s66, 1
    buffer_load_dwordx4 v2, s[8:11], s67 offen sc1 lds
    s_add_u32 s67, s67, 1024
    s_mul_i32 s49, s66, 43
    s_lshr_b32 s49, s49, 9
    s_min_u32 s49, s49, 4
    s_mul_i32 s49, s49, 2160
    s_lshl_b32 s65, s66, 10
    s_add_u32 s49, s49, s65
    s_add_u32 m0, s49, 2304
    s_add_u32 s66, s66, 1
    buffer_load_dwordx4 v2, s[8:11], s67 offen sc1 lds
    s_add_u32 s67, s67, 1024
    s_mul_i32 s49, s66, 43
    s_lshr_b32 s49, s49, 9
    s_min_u32 s49, s49, 4
    s_mul_i32 s49, s49, 2160
    s_lshl_b32 s65, s66, 10
    s_add_u32 s49, s49, s65
    s_add_u32 m0, s49, 2304
    s_add_u32 s66, s66, 1
    buffer_load_dwordx4 v2, s[8:11], s67 offen sc1 lds
    s_add_u32 s67, s67, 1024
    s_mul_i32 s49, s66, 43
    s_lshr_b32 s49, s49, 9
    s_min_u32 s49, s49, 4
    s_mul_i32 s49, s49, 2160
    s_lshl_b32 s65, s66, 10
    s_add_u32 s49, s49, s65
    s_add_u32 m0, s49, 2304
    s_add_u32 s66, s66, 1
    buffer_load_dwordx4 v2, s[8:11], s67 offen sc1 lds
    s_add_u32 s67, s67, 1024
    s_mul_i32 s49, s66, 43
    s_lshr_b32 s49, s49, 9
    s_min_u32 s49, s49, 4
    s_mul_i32 s49, s49, 2160
    s_lshl_b32 s65, s66, 10
    s_add_u32 s49, s49, s65
    s_add_u32 m0, s49, 2304
    s_add_u32 s66, s66, 1
    buffer_load_dwordx4 v2, s[8:11], s67 offen sc1 lds
    s_add_u32 s67, s67, 1024
    s_mul_i32 s49, s66, 43
    s_lshr_b32 s49, s49, 9
    s_min_u32 s49, s49, 4
    s_mul_i32 s49, s49, 2160
    s_lshl_b32 s65, s66, 10
    s_add_u32 s49, s49, s65
    s_add_u32 m0, s49, 2304
    s_add_u32 s66, s66, 1
    buffer_load_dwordx4 v2, s[8:11], s67 offen sc1 lds
    s_add_u32 s67, s67, 1024
    s_mul_i32 s49, s66, 43
    s_lshr_b32 s49, s49, 9
    s_min_u32 s49, s49, 4
    s_mul_i32 s49, s49, 2160
    s_lshl_b32 s65, s66, 10
    s_add_u32 s49, s49, s65
    s_add_u32 m0, s49, 2304
    s_add_u32 s66, s66, 1
    buffer_load_dwordx4 v2, s[8:11], s67 offen sc1 lds
    s_add_u32 s67, s67, 1024
    s_mul_i32 s49, s66, 43
    s_lshr_b32 s49, s49, 9
    s_min_u32 s49, s49, 4
    s_mul_i32 s49, s49, 2160
    s_lshl_b32 s65, s66, 10
    s_add_u32 s49, s49, s65
    s_add_u32 m0, s49, 2304
    s_add_u32 s66, s66, 1
    buffer_load_dwordx4 v2, s[8:11], s67 offen sc1 lds
    s_mov_b32 s28, s82
    s_mov_b32 s29, s83
    s_mov_b32 s30, 0x00271000
    s_mov_b32 s31, 0x20000
    s_and_b32 s64, s36, 3
    s_mul_i32 s65, s64, 14448
    s_add_u32 s65, s65, 2304
    s_mov_b32 s69, 0x3c000000
    s_mov_b32 s70, 0x3727c5ac
    s_mov_b32 s71, 0x3fb8aa3b
    s_mul_i32 s68, s2, 10240
    v_and_b32 v8, 15, v1
    v_lshrrev_b32 v9, 4, v1
    v_and_b32 v3, 7, v8
    v_mul_u32_u24 v10, 2064, v3
    v_add_u32 v10, 80000, v10
    v_mov_b32 v7, 240
    v_cmp_eq_u32 vcc, 7, v3
    s_nop 1
    v_cndmask_b32 v10, v10, v7, vcc
    s_lshl_b32 s49, s64, 4
    v_add_u32 v10, s49, v10
    v_lshl_add_u32 v10, v9, 7, v10
    v_lshrrev_b32 v4, 3, v8
    v_lshl_add_u32 v10, v4, 3, v10
    v_lshrrev_b32 v5, 1, v9
    v_cmp_eq_u32 s[72:73], v4, v5
    s_nop 1
    v_cndmask_b32 v11, 0, 1.0, s[72:73]
    s_mov_b32 s66, 0
    s_mov_b32 s67, 0
    s_cmp_ge_u32 s36, 4
    s_cbranch_scc1 KZ
    v_add_u32 v12, s65, v2
    v_lshrrev_b32 v3, 2, v8
    v_lshl_add_u32 v3, v3, 4, v8
    v_lshlrev_b32 v3, 4, v3
    v_and_b32 v4, 3, v8
    v_lshl_add_u32 v3, v4, 2, v3
    v_add_u32 v13, s65, v3
    v_lshlrev_b32 v3, 2, v8
    v_add_u32 v14, s65, v3
    v_lshlrev_b32 v3, 4, v9
    v_add_u32 v15, s65, v3
    v_lshrrev_b32 v3, 2, v8
    v_lshlrev_b32 v3, 8, v3
    v_lshl_add_u32 v3, v4, 2, v3
    v_add_u32 v3, 1024, v3
    v_add_u32 v116, s65, v3
    v_lshlrev_b32 v3, 8, v9
    v_add_u32 v3, 1168, v3
    v_add_u32 v119, s65, v3
    v_mov_b32 v117, v12
    v_lshl_add_u32 v118, v8, 4, s65
    v_mov_b32 v98, s47
    s_mov_b32 s49, 256000
    buffer_load_dwordx4 v[32:35], v2, s[8:11], s49 offen offset:0 sc1
    buffer_load_dwordx4 v[36:39], v2, s[8:11], s49 offen offset:1024 sc1
    buffer_load_dwordx4 v[40:43], v2, s[8:11], s49 offen offset:2048 sc1
    buffer_load_dwordx4 v[44:47], v2, s[8:11], s49 offen offset:3072 sc1
    s_waitcnt vmcnt(4)
    s_barrier
    v_add_u32 v3, 32768, v2
    ds_read_b128 v[128:131], v2 offset:2304
    ds_read_b128 v[132:135], v2 offset:3328
    ds_read_b128 v[136:139], v2 offset:4352
    ds_read_b128 v[140:143], v2 offset:5376
    ds_read_b128 v[144:147], v2 offset:6400
    ds_read_b128 v[148:151], v2 offset:7424
    ds_read_b128 v[152:155], v2 offset:8448
    ds_read_b128 v[156:159], v2 offset:9472
    ds_read_b128 v[160:163], v2 offset:10496
    ds_read_b128 v[164:167], v2 offset:11520
    ds_read_b128 v[168:171], v2 offset:12544
    ds_read_b128 v[172:175], v2 offset:13568
    ds_read_b128 v[176:179], v2 offset:16752
    ds_read_b128 v[180:183], v2 offset:17776
    ds_read_b128 v[184:187], v2 offset:18800
    ds_read_b128 v[188:191], v2 offset:19824
    ds_read_b128 v[192:195], v2 offset:20848
    ds_read_b128 v[196:199], v2 offset:21872
    ds_read_b128 v[200:203], v2 offset:22896
    ds_read_b128 v[204:207], v2 offset:23920
    ds_read_b128 v[208:211], v2 offset:24944
    ds_read_b128 v[212:215], v2 offset:25968
    ds_read_b128 v[216:219], v2 offset:26992
    ds_read_b128 v[220:223], v2 offset:28016
    ds_read_b128 v[224:227], v2 offset:31200
    ds_read_b128 v[228:231], v2 offset:32224
    ds_read_b128 v[232:235], v2 offset:33248
    ds_read_b128 v[236:239], v2 offset:34272
    ds_read_b128 v[240:243], v2 offset:35296
    ds_read_b128 v[244:247], v2 offset:36320
    ds_read_b128 v[248:251], v2 offset:37344
    ds_read_b128 v[252:255], v2 offset:38368
    s_waitcnt vmcnt(0) lgkmcnt(0)
    s_barrier
    ds_read_b64 v[16:17], v10 offset:0
    ds_read_b64 v[18:19], v10 offset:64
    ds_read_b64 v[20:21], v10 offset:512
    ds_read_b64 v[22:23], v10 offset:576
    ds_read_b64 v[24:25], v10 offset:1024
    ds_read_b64 v[26:27], v10 offset:1088
    ds_read_b64 v[28:29], v10 offset:1536
    ds_read_b64 v[30:31], v10 offset:1600
    v_add_u32 v10, 14448, v10
    s_waitcnt lgkmcnt(0)
    v_mfma_f32_16x16x32_bf16 v[76:79], v[16:19], v[16:19], 0
    v_mfma_f32_16x16x32_bf16 v[76:79], v[20:23], v[20:23], v[76:79]
    v_mfma_f32_16x16x32_bf16 v[76:79], v[24:27], v[24:27], v[76:79]
    v_mfma_f32_16x16x32_bf16 v[76:79], v[28:31], v[28:31], v[76:79]
    v_mfma_f32_16x16x32_bf16 v[80:83], v[16:19], v[32:35], 0
    v_mfma_f32_16x16x32_bf16 v[80:83], v[20:23], v[36:39], v[80:83]
    v_mfma_f32_16x16x32_bf16 v[80:83], v[24:27], v[40:43], v[80:83]
    v_mfma_f32_16x16x32_bf16 v[80:83], v[28:31], v[44:47], v[80:83]
    v_mfma_f32_16x16x32_bf16 v[64:67], v[128:131], v[16:19], 0
    v_mfma_f32_16x16x32_bf16 v[64:67], v[132:135], v[20:23], v[64:67]
    v_mfma_f32_16x16x32_bf16 v[64:67], v[136:139], v[24:27], v[64:67]
    v_mfma_f32_16x16x32_bf16 v[64:67], v[140:143], v[28:31], v[64:67]
    v_mfma_f32_16x16x32_bf16 v[68:71], v[144:147], v[16:19], 0
    v_mfma_f32_16x16x32_bf16 v[68:71], v[148:151], v[20:23], v[68:71]
    v_mfma_f32_16x16x32_bf16 v[68:71], v[152:155], v[24:27], v[68:71]
    v_mfma_f32_16x16x32_bf16 v[68:71], v[156:159], v[28:31], v[68:71]
    v_mfma_f32_16x16x32_bf16 v[72:75], v[160:163], v[16:19], 0
    v_mfma_f32_16x16x32_bf16 v[72:75], v[164:167], v[20:23], v[72:75]
    v_mfma_f32_16x16x32_bf16 v[72:75], v[168:171], v[24:27], v[72:75]
    v_mfma_f32_16x16x32_bf16 v[72:75], v[172:175], v[28:31], v[72:75]
    v_cvt_pk_bf16_f32 v48, v64, v65
    v_cvt_pk_bf16_f32 v49, v66, v67
    v_mfma_f32_16x16x32_bf16 v[64:67], v[176:179], v[16:19], 0
    v_mfma_f32_16x16x32_bf16 v[64:67], v[180:183], v[20:23], v[64:67]
    v_mfma_f32_16x16x32_bf16 v[64:67], v[184:187], v[24:27], v[64:67]
    v_mfma_f32_16x16x32_bf16 v[64:67], v[188:191], v[28:31], v[64:67]
    v_cvt_pk_bf16_f32 v50, v68, v69
    v_cvt_pk_bf16_f32 v51, v70, v71
KU_L:
    s_setprio 2
    ds_write_b128 v12, v[76:79]
    ds_write_b128 v12, v[80:83] offset:1024
    ds_read_b32 v113, v13
    ds_read2_b32 v[84:85], v116 offset0:0 offset1:4
    ds_read_b32 v86, v116 offset:80
    ds_read_b128 v[104:107], v119
    v_cvt_pk_bf16_f32 v52, v72, v73
    v_cvt_pk_bf16_f32 v53, v74, v75
    v_mfma_f32_16x16x32_bf16 v[68:71], v[192:195], v[16:19], 0
    v_mfma_f32_16x16x32_bf16 v[68:71], v[196:199], v[20:23], v[68:71]
    v_mfma_f32_16x16x32_bf16 v[68:71], v[200:203], v[24:27], v[68:71]
    v_mfma_f32_16x16x32_bf16 v[68:71], v[204:207], v[28:31], v[68:71]
    v_cvt_pk_bf16_f32 v54, v64, v65
    v_cvt_pk_bf16_f32 v55, v66, v67
    v_cvt_pk_bf16_f32 v108, v80, v81
    v_cvt_pk_bf16_f32 v109, v82, v83
    s_waitcnt lgkmcnt(0)
    v_mul_f32 v113, s69, v113
    v_mfma_f32_16x16x32_bf16 v[72:75], v[208:211], v[16:19], 0
    v_fma_f32 v113, -v84, v84, v113
    v_mfma_f32_16x16x32_bf16 v[72:75], v[212:215], v[20:23], v[72:75]
    v_max_f32 v113, 0, v113
    v_mfma_f32_16x16x32_bf16 v[72:75], v[216:219], v[24:27], v[72:75]
    v_add_f32 v113, s70, v113
    v_mfma_f32_16x16x32_bf16 v[72:75], v[220:223], v[28:31], v[72:75]
    v_rsq_f32 v112, v113
    v_add_f32 v85, v85, v86
    v_cvt_pk_bf16_f32 v56, v68, v69
    ds_write_b32 v14, v112 offset:2048
    ds_read_b128 v[92:95], v15 offset:2048
    v_cvt_pk_bf16_f32 v57, v70, v71
    v_mfma_f32_16x16x32_bf16 v[64:67], v[224:227], v[16:19], 0
    v_mfma_f32_16x16x32_bf16 v[64:67], v[228:231], v[20:23], v[64:67]
    v_mfma_f32_16x16x32_bf16 v[64:67], v[232:235], v[24:27], v[64:67]
    v_mfma_f32_16x16x32_bf16 v[64:67], v[236:239], v[28:31], v[64:67]
    v_cvt_pk_bf16_f32 v58, v72, v73
    v_cvt_pk_bf16_f32 v59, v74, v75
    v_mfma_f32_16x16x32_bf16 v[68:71], v[240:243], v[16:19], 0
    v_mfma_f32_16x16x32_bf16 v[68:71], v[244:247], v[20:23], v[68:71]
    v_mfma_f32_16x16x32_bf16 v[68:71], v[248:251], v[24:27], v[68:71]
    v_mfma_f32_16x16x32_bf16 v[68:71], v[252:255], v[28:31], v[68:71]
    s_nop 1
    v_cvt_pk_bf16_f32 v60, v64, v65
    v_cvt_pk_bf16_f32 v61, v66, v67
    s_waitcnt lgkmcnt(0)
    s_nop 2
    v_cvt_pk_bf16_f32 v62, v68, v69
    v_cvt_pk_bf16_f32 v63, v70, v71
    v_mfma_f32_16x16x32_bf16 v[88:91], v[16:19], v[48:51], 0
    v_mfma_f32_16x16x32_bf16 v[88:91], v[20:23], v[52:55], v[88:91]
    v_mfma_f32_16x16x32_bf16 v[88:91], v[24:27], v[56:59], v[88:91]
    v_mfma_f32_16x16x32_bf16 v[88:91], v[28:31], v[60:63], v[88:91]
    s_setprio 0
    s_add_u32 s66, s66, 1
    s_cmp_eq_u32 s66, 5
    s_cbranch_scc1 KU_E
    ds_read_b64 v[16:17], v10 offset:0
    ds_read_b64 v[18:19], v10 offset:64
    ds_read_b64 v[20:21], v10 offset:512
    ds_read_b64 v[22:23], v10 offset:576
    ds_read_b64 v[24:25], v10 offset:1024
    ds_read_b64 v[26:27], v10 offset:1088
    ds_read_b64 v[28:29], v10 offset:1536
    ds_read_b64 v[30:31], v10 offset:1600
    v_add_u32 v10, 14448, v10
    s_waitcnt lgkmcnt(0)
    v_mfma_f32_16x16x32_bf16 v[76:79], v[16:19], v[16:19], 0
    v_mfma_f32_16x16x32_bf16 v[76:79], v[20:23], v[20:23], v[76:79]
    v_fma_f32 v88, -v84, v104, v88
    v_fma_f32 v89, -v84, v105, v89
    v_fma_f32 v90, -v84, v106, v90
    v_fma_f32 v91, -v84, v107, v91
    v_mul_f32 v88, v88, v92
    v_mul_f32 v89, v89, v93
    v_mul_f32 v90, v90, v94
    v_mul_f32 v91, v91, v95
    v_max3_f32 v114, v88, v89, v90
    v_max_f32 v114, v114, v91
    v_mov_b32 v115, v114
    v_mfma_f32_16x16x32_bf16 v[76:79], v[24:27], v[24:27], v[76:79]
    v_mfma_f32_16x16x32_bf16 v[76:79], v[28:31], v[28:31], v[76:79]
    v_permlane16_swap_b32 v114, v115
    v_max_f32 v114, v114, v115
    v_mfma_f32_16x16x32_bf16 v[80:83], v[16:19], v[32:35], 0
    v_mul_f32 v114, v114, v112
    v_fma_f32 v88, v88, v112, -v114
    v_fma_f32 v89, v89, v112, -v114
    v_fma_f32 v90, v90, v112, -v114
    v_fma_f32 v91, v91, v112, -v114
    v_mfma_f32_16x16x32_bf16 v[80:83], v[20:23], v[36:39], v[80:83]
    v_mfma_f32_16x16x32_bf16 v[80:83], v[24:27], v[40:43], v[80:83]
    v_exp_f32 v88, v88
    v_mfma_f32_16x16x32_bf16 v[80:83], v[28:31], v[44:47], v[80:83]
    v_exp_f32 v89, v89
    v_mfma_f32_16x16x32_bf16 v[64:67], v[128:131], v[16:19], 0
    v_exp_f32 v90, v90
    v_mfma_f32_16x16x32_bf16 v[64:67], v[132:135], v[20:23], v[64:67]
    v_exp_f32 v91, v91
    v_mfma_f32_16x16x32_bf16 v[64:67], v[136:139], v[24:27], v[64:67]
    v_add_f32 v114, v88, v89
    v_add_f32 v115, v90, v91
    v_mfma_f32_16x16x32_bf16 v[64:67], v[140:143], v[28:31], v[64:67]
    v_add_f32 v114, v114, v115
    v_mov_b32 v115, v114
    v_mul_f32 v88, v88, v92
    v_mul_f32 v89, v89, v93
    v_mfma_f32_16x16x32_bf16 v[68:71], v[144:147], v[16:19], 0
    v_permlane16_swap_b32 v114, v115
    v_mul_f32 v90, v90, v94
    v_mul_f32 v91, v91, v95
    v_mfma_f32_16x16x32_bf16 v[68:71], v[148:151], v[20:23], v[68:71]
    v_add_f32 v114, v114, v115
    v_rcp_f32 v114, v114
    v_mfma_f32_16x16x32_bf16 v[68:71], v[152:155], v[24:27], v[68:71]
    v_mul_f32 v114, v114, v11
    v_mul_f32 v100, v88, v114
    v_mul_f32 v101, v89, v114
    v_mul_f32 v102, v90, v114
    v_mul_f32 v103, v91, v114
    v_mfma_f32_16x16x32_bf16 v[68:71], v[156:159], v[28:31], v[68:71]
    v_cvt_pk_bf16_f32 v110, v100, v101
    v_cvt_pk_bf16_f32 v111, v102, v103
    ds_write_b128 v117, v[100:103] offset:3200
    v_mfma_f32_16x16x32_bf16 v[72:75], v[160:163], v[16:19], 0
    v_mfma_f32_16x16x16_bf16 v[104:107], v[108:109], v[110:111], 0
    v_mfma_f32_16x16x32_bf16 v[72:75], v[164:167], v[20:23], v[72:75]
    v_mfma_f32_16x16x32_bf16 v[72:75], v[168:171], v[24:27], v[72:75]
    v_mfma_f32_16x16x32_bf16 v[72:75], v[172:175], v[28:31], v[72:75]
    v_cvt_pk_bf16_f32 v48, v64, v65
    v_cvt_pk_bf16_f32 v49, v66, v67
    v_mfma_f32_16x16x32_bf16 v[64:67], v[176:179], v[16:19], 0
    v_mfma_f32_16x16x32_bf16 v[64:67], v[180:183], v[20:23], v[64:67]
    v_mfma_f32_16x16x32_bf16 v[64:67], v[184:187], v[24:27], v[64:67]
    v_add_f32 v96, v84, v106
    v_add_f32 v97, v85, v107
    v_mul_f32 v97, s71, v97
    ds_write_b96 v118, v[96:98] offset:4224
    v_add_u32 v117, 1280, v117
    v_add_u32 v118, 1280, v118
    v_mfma_f32_16x16x32_bf16 v[64:67], v[188:191], v[28:31], v[64:67]
    v_cvt_pk_bf16_f32 v50, v68, v69
    v_cvt_pk_bf16_f32 v51, v70, v71
    s_branch KU_L
KU_E:
    s_nop 3
    v_fma_f32 v88, -v84, v104, v88
    v_fma_f32 v89, -v84, v105, v89
    v_fma_f32 v90, -v84, v106, v90
    v_fma_f32 v91, -v84, v107, v91
    v_mul_f32 v88, v88, v92
    v_mul_f32 v89, v89, v93
    v_mul_f32 v90, v90, v94
    v_mul_f32 v91, v91, v95
    v_max3_f32 v114, v88, v89, v90
    v_max_f32 v114, v114, v91
    v_mov_b32 v115, v114
    s_nop 1
    v_permlane16_swap_b32 v114, v115
    v_max_f32 v114, v114, v115
    v_mul_f32 v114, v114, v112
    v_fma_f32 v88, v88, v112, -v114
    v_fma_f32 v89, v89, v112, -v114
    v_fma_f32 v90, v90, v112, -v114
    v_fma_f32 v91, v91, v112, -v114
    v_exp_f32 v88, v88
    v_exp_f32 v89, v89
    v_exp_f32 v90, v90
    v_exp_f32 v91, v91
    v_add_f32 v114, v88, v89
    v_add_f32 v115, v90, v91
    v_add_f32 v114, v114, v115
    v_mov_b32 v115, v114
    v_mul_f32 v88, v88, v92
    v_mul_f32 v89, v89, v93
    v_permlane16_swap_b32 v114, v115
    v_mul_f32 v90, v90, v94
    v_mul_f32 v91, v91, v95
    v_add_f32 v114, v114, v115
    v_rcp_f32 v114, v114
    s_nop 0
    v_mul_f32 v114, v114, v11
    v_mul_f32 v100, v88, v114
    v_mul_f32 v101, v89, v114
    v_mul_f32 v102, v90, v114
    v_mul_f32 v103, v91, v114
    v_cvt_pk_bf16_f32 v110, v100, v101
    v_cvt_pk_bf16_f32 v111, v102, v103
    ds_write_b128 v117, v[100:103] offset:3200
    s_nop 0
    v_mfma_f32_16x16x16_bf16 v[104:107], v[108:109], v[110:111], 0
    s_nop 7
    v_add_f32 v96, v84, v106
    v_add_f32 v97, v85, v107
    v_mul_f32 v97, s71, v97
    ds_write_b96 v118, v[96:98] offset:4224
    v_add_u32 v117, 1280, v117
    v_add_u32 v118, 1280, v118
    s_branch K_FIN
KZ:
    s_setprio 0
    v_and_b32 v3, 1, v9
    v_lshlrev_b32 v3, 2, v3
    v_lshrrev_b32 v4, 2, v8
    v_add_u32 v3, v3, v4
    v_mul_u32_u24 v12, 2064, v3
    v_add_u32 v12, 80000, v12
    v_mov_b32 v7, 240
    v_cmp_eq_u32 vcc, 7, v3
    s_nop 1
    v_cndmask_b32 v12, v12, v7, vcc
    s_lshl_b32 s49, s64, 4
    v_add_u32 v12, s49, v12
    v_and_b32 v4, 3, v8
    v_lshl_add_u32 v12, v4, 6, v12
    v_lshl_add_u32 v12, v5, 3, v12
    v_lshlrev_b32 v3, 2, v9
    v_sub_u32 v3, v8, v3
    v_mov_b32 v4, 0x3f80
    v_mov_b32 v6, 0x3f800000
    v_cmp_eq_u32 vcc, 0, v3
    s_nop 1
    v_cndmask_b32 v86, 0, v4, vcc
    v_cmp_eq_u32 vcc, 1, v3
    s_nop 1
    v_cndmask_b32 v86, v86, v6, vcc
    v_cmp_eq_u32 vcc, 2, v3
    s_nop 1
    v_cndmask_b32 v87, 0, v4, vcc
    v_cmp_eq_u32 vcc, 3, v3
    s_nop 1
    v_cndmask_b32 v87, v87, v6, vcc
    v_lshlrev_b32 v3, 4, v9
    v_add_u32 v4, 2624, v3
    v_mov_b32 v6, 2112
    v_cndmask_b32 v13, v6, v4, s[72:73]
    v_add_u32 v13, s65, v13
    v_and_b32 v4, 7, v8
    v_sub_u32 v4, 7, v4
    v_lshlrev_b32 v4, 6, v4
    v_mov_b32 v6, 512
    v_cndmask_b32 v4, v6, v4, s[72:73]
    v_add3_u32 v15, v4, v3, s65
    v_add_u32 v15, 2176, v15
    v_lshrrev_b32 v3, 2, v8
    v_lshlrev_b32 v3, 4, v3
    v_and_b32 v4, 3, v8
    v_lshl_add_u32 v3, v4, 1, v3
    v_add_u32 v3, 2624, v3
    v_add_u32 v14, s65, v3
    v_lshrrev_b32 v3, 3, v8
    v_lshlrev_b32 v32, 8, v3
    v_and_b32 v4, 7, v8
    v_lshl_add_u32 v32, v4, 5, v32
    v_lshl_add_u32 v32, v9, 3, v32
    s_lshl_b32 s49, s64, 9
    v_add_u32 v32, s49, v32
    v_add_u32 v33, s65, v2
    v_lshl_add_u32 v34, v8, 4, s65
    s_mov_b32 s67, 1048576
    v_mov_b32 v92, 0
    v_mov_b32 v93, 0
    v_mov_b32 v94, 0
    v_mov_b32 v95, 0
    s_cmp_eq_u32 s45, 0
    s_cbranch_scc1 KT_N0
    v_and_b32 v3, 7, v1
    v_lshlrev_b32 v3, 3, v3
    v_lshrrev_b32 v4, 3, v1
    v_lshl_add_u32 v3, v4, 7, v3
    s_and_b32 s49, s36, 3
    s_mul_i32 s49, s49, 14448
    s_add_u32 s49, s49, 80000
    v_add_u32 v3, s49, v3
    ds_write_b64 v3, v[44:45] offset:0
    ds_write_b64 v3, v[46:47] offset:64
    ds_write_b64 v3, v[48:49] offset:1024
    ds_write_b64 v3, v[50:51] offset:1088
    s_cmp_lg_u32 s36, 4
    s_cbranch_scc1 KT_T0
    ds_write_b64 v3, v[52:53] offset:57792
    ds_write_b64 v3, v[54:55] offset:57856
    ds_write_b64 v3, v[56:57] offset:58816
    ds_write_b64 v3, v[58:59] offset:58880
KT_T0:
KT_N0:
    s_min_u32 s49, s58, 5
    s_mul_i32 s49, s49, 16384
    s_add_u32 s49, s49, s94
    v_mov_b32 v121, 0
    s_mov_b32 exec_hi, 0
    buffer_load_dwordx2 v[120:121], v62, s[8:11], s49 offen sc1
    s_mov_b64 exec, -1
    s_waitcnt vmcnt(0)
    s_cmp_gt_u32 s58, 5
    s_cbranch_scc1 KT_N5
    v_cmp_eq_u32 vcc, s46, v120
    v_cmp_eq_u32 s[62:63], s47, v121
    s_nop 0
    s_and_b64 vcc, vcc, s[62:63]
    s_cmp_eq_u32 vcc_lo, -1
    s_cbranch_scc0 KT_N5
    s_mul_i32 s49, s58, 2560000
    s_add_u32 s49, s49, s95
    s_mul_i32 s50, s58, 2064
    s_add_u32 s50, s50, 80000
    s_cmp_eq_u32 s58, 7
    s_cmov_b32 s50, 240
    s_add_u32 m0, s50, s96
    s_add_u32 s58, s58, 1
    buffer_load_dwordx4 v2, s[20:23], s49 offen sc1 lds
    buffer_load_dwordx4 v2, s[20:23], s49 offen offset:1024 sc1 lds
    s_cmp_lg_u32 s36, 4
    s_cbranch_scc1 KTD10
    s_add_u32 m0, s50, 57792
    s_add_u32 s49, s49, 8192
    buffer_load_dwordx4 v2, s[20:23], s49 offen sc1 lds
    buffer_load_dwordx4 v2, s[20:23], s49 offen offset:1024 sc1 lds
KTD10:
KT_N5:
    s_barrier
    s_add_u32 s94, s94, 114688
    v_mov_b32 v121, 0
    s_mov_b32 exec_hi, 0
    buffer_load_dwordx2 v[120:121], v62, s[8:11], s94 offen sc1
    s_mov_b64 exec, -1
    v_add_u32 v3, 32768, v2
    ds_read_b128 v[128:131], v2 offset:39392
    ds_read_b128 v[132:135], v2 offset:40416
    ds_read_b128 v[136:139], v2 offset:41440
    ds_read_b128 v[140:143], v2 offset:42464
    ds_read_b128 v[144:147], v2 offset:45648
    ds_read_b128 v[148:151], v2 offset:46672
    ds_read_b128 v[152:155], v2 offset:47696
    ds_read_b128 v[156:159], v2 offset:48720
    ds_read_b128 v[160:163], v2 offset:49744
    ds_read_b128 v[164:167], v2 offset:50768
    ds_read_b128 v[168:171], v2 offset:51792
    ds_read_b128 v[172:175], v2 offset:52816
    ds_read_b128 v[176:179], v2 offset:53840
    ds_read_b128 v[180:183], v2 offset:54864
    ds_read_b128 v[184:187], v2 offset:55888
    ds_read_b128 v[188:191], v2 offset:56912
    ds_read_b128 v[192:195], v2 offset:60096
    ds_read_b128 v[196:199], v2 offset:61120
    ds_read_b128 v[200:203], v2 offset:62144
    ds_read_b128 v[204:207], v2 offset:63168
    ds_read_b128 v[208:211], v2 offset:64192
    ds_read_b128 v[212:215], v2 offset:65216
    ds_read_b128 v[216:219], v3 offset:33472
    ds_read_b128 v[220:223], v3 offset:34496
    ds_read_b128 v[224:227], v3 offset:35520
    ds_read_b128 v[228:231], v3 offset:36544
    ds_read_b128 v[232:235], v3 offset:37568
    ds_read_b128 v[236:239], v3 offset:38592
    ds_read_b128 v[240:243], v3 offset:39616
    ds_read_b128 v[244:247], v3 offset:40640
    ds_read_b128 v[248:251], v3 offset:41664
    ds_read_b128 v[252:255], v3 offset:42688
    s_waitcnt vmcnt(0)
    v_cmp_eq_u32 vcc, s46, v120
    v_cmp_eq_u32 s[62:63], s47, v121
    s_nop 0
    s_and_b64 vcc, vcc, s[62:63]
    s_cmp_eq_u32 vcc_lo, -1
    s_cbranch_scc1 KT_T2
    s_cmp_lg_u32 s40, 0
    s_cbranch_scc1 KT_HP_X
    s_add_u32 s97, s46, 0
    s_mov_b32 s52, 0
    s_mov_b32 exec_hi, 0
KT_HP_L:
    buffer_load_dwordx2 v[120:121], v62, s[8:11], s94 offen sc1
    s_waitcnt vmcnt(0)
    v_subrev_u32 v120, s97, v120
    v_cmp_gt_u32 vcc, 64, v120
    v_cmp_eq_u32 s[62:63], s47, v121
    s_nop 0
    s_and_b64 vcc, vcc, s[62:63]
    s_cmp_eq_u64 vcc, exec
    s_cbranch_scc1 KT_HP_D
    s_add_u32 s52, s52, 1
    s_cmp_lt_u32 s52, 1048576
    s_cbranch_scc1 KT_HP_L
    s_mov_b32 s40, 1
KT_HP_D:
    s_mov_b64 exec, -1
KT_HP_X:
KT_T2:
    s_mul_i32 s49, s58, 2560000
    s_add_u32 s49, s49, s95
    s_mul_i32 s50, s58, 2064
    s_add_u32 s50, s50, 80000
    s_cmp_eq_u32 s58, 7
    s_cmov_b32 s50, 240
    s_add_u32 m0, s50, s96
    s_add_u32 s58, s58, 1
    buffer_load_dwordx4 v2, s[20:23], s49 offen sc1 lds
    buffer_load_dwordx4 v2, s[20:23], s49 offen offset:1024 sc1 lds
    s_cmp_lg_u32 s36, 4
    s_cbranch_scc1 KTD11
    s_add_u32 m0, s50, 57792
    s_add_u32 s49, s49, 8192
    buffer_load_dwordx4 v2, s[20:23], s49 offen sc1 lds
    buffer_load_dwordx4 v2, s[20:23], s49 offen offset:1024 sc1 lds
KTD11:
    s_cmp_lt_u32 s58, 8
    s_cbranch_scc1 KT_T2
    s_waitcnt vmcnt(0) lgkmcnt(0)
    s_barrier
    ds_write_b128 v33, v[92:95] offset:2176
    ds_read_b64 v[16:17], v10 offset:0
    ds_read_b64 v[18:19], v10 offset:64
    ds_read_b64 v[20:21], v10 offset:512
    ds_read_b64 v[22:23], v10 offset:576
    ds_read_b64 v[24:25], v10 offset:1024
    ds_read_b64 v[26:27], v10 offset:1088
    ds_read_b64 v[28:29], v10 offset:1536
    ds_read_b64 v[30:31], v10 offset:1600
    ds_read_b64_tr_b16 v[38:39], v12 offset:0
    ds_read_b64_tr_b16 v[44:45], v12 offset:256
    ds_read_b64_tr_b16 v[50:51], v12 offset:512
    ds_read_b64_tr_b16 v[56:57], v12 offset:768
    ds_read_b64_tr_b16 v[62:63], v12 offset:1024
    ds_read_b64_tr_b16 v[68:69], v12 offset:1280
    ds_read_b64_tr_b16 v[74:75], v12 offset:1536
    ds_read_b64_tr_b16 v[80:81], v12 offset:1792
    v_add_u32 v10, 14448, v10
    v_add_u32 v12, 14448, v12
    s_waitcnt lgkmcnt(8)
    v_mfma_f32_16x16x32_bf16 v[92:95], v[16:19], v[128:131], 0
    v_mfma_f32_16x16x32_bf16 v[92:95], v[20:23], v[132:135], v[92:95]
    v_mfma_f32_16x16x32_bf16 v[92:95], v[24:27], v[136:139], v[92:95]
    v_mfma_f32_16x16x32_bf16 v[92:95], v[28:31], v[140:143], v[92:95]
    v_mfma_f32_16x16x32_bf16 v[96:99], v[16:19], v[144:147], 0
    v_mfma_f32_16x16x32_bf16 v[96:99], v[20:23], v[148:151], v[96:99]
    v_mfma_f32_16x16x32_bf16 v[96:99], v[24:27], v[152:155], v[96:99]
    v_mfma_f32_16x16x32_bf16 v[96:99], v[28:31], v[156:159], v[96:99]
    v_mfma_f32_16x16x32_bf16 v[100:103], v[16:19], v[160:163], 0
    v_mfma_f32_16x16x32_bf16 v[100:103], v[20:23], v[164:167], v[100:103]
    v_mfma_f32_16x16x32_bf16 v[100:103], v[24:27], v[168:171], v[100:103]
    v_mfma_f32_16x16x32_bf16 v[100:103], v[28:31], v[172:175], v[100:103]
    v_cvt_pk_bf16_f32 v36, v92, v93
    v_cvt_pk_bf16_f32 v37, v94, v95
    v_mfma_f32_16x16x32_bf16 v[92:95], v[16:19], v[176:179], 0
    v_mfma_f32_16x16x32_bf16 v[92:95], v[20:23], v[180:183], v[92:95]
    v_mfma_f32_16x16x32_bf16 v[92:95], v[24:27], v[184:187], v[92:95]
    v_mfma_f32_16x16x32_bf16 v[92:95], v[28:31], v[188:191], v[92:95]
    v_cvt_pk_bf16_f32 v42, v96, v97
    v_cvt_pk_bf16_f32 v43, v98, v99
    v_mfma_f32_16x16x32_bf16 v[96:99], v[16:19], v[192:195], 0
    v_mfma_f32_16x16x32_bf16 v[96:99], v[20:23], v[196:199], v[96:99]
    v_mfma_f32_16x16x32_bf16 v[96:99], v[24:27], v[200:203], v[96:99]
    v_mfma_f32_16x16x32_bf16 v[96:99], v[28:31], v[204:207], v[96:99]
    v_cvt_pk_bf16_f32 v48, v100, v101
    v_cvt_pk_bf16_f32 v49, v102, v103
    v_mfma_f32_16x16x32_bf16 v[100:103], v[16:19], v[208:211], 0
    v_mfma_f32_16x16x32_bf16 v[100:103], v[20:23], v[212:215], v[100:103]
    v_mfma_f32_16x16x32_bf16 v[100:103], v[24:27], v[216:219], v[100:103]
    v_mfma_f32_16x16x32_bf16 v[100:103], v[28:31], v[220:223], v[100:103]
    v_cvt_pk_bf16_f32 v54, v92, v93
    v_cvt_pk_bf16_f32 v55, v94, v95
    v_mfma_f32_16x16x32_bf16 v[92:95], v[16:19], v[224:227], 0
    v_mfma_f32_16x16x32_bf16 v[92:95], v[20:23], v[228:231], v[92:95]
    v_mfma_f32_16x16x32_bf16 v[92:95], v[24:27], v[232:235], v[92:95]
    v_mfma_f32_16x16x32_bf16 v[92:95], v[28:31], v[236:239], v[92:95]
    v_cvt_pk_bf16_f32 v60, v96, v97
    v_cvt_pk_bf16_f32 v61, v98, v99
    v_mfma_f32_16x16x32_bf16 v[96:99], v[16:19], v[240:243], 0
    v_mfma_f32_16x16x32_bf16 v[96:99], v[20:23], v[244:247], v[96:99]
    v_mfma_f32_16x16x32_bf16 v[96:99], v[24:27], v[248:251], v[96:99]
    v_mfma_f32_16x16x32_bf16 v[96:99], v[28:31], v[252:255], v[96:99]
    v_cvt_pk_bf16_f32 v66, v100, v101
    v_cvt_pk_bf16_f32 v67, v102, v103
    v_cvt_pk_bf16_f32 v72, v92, v93
    v_cvt_pk_bf16_f32 v73, v94, v95
    s_nop 3
    v_cvt_pk_bf16_f32 v78, v96, v97
    v_cvt_pk_bf16_f32 v79, v98, v99
    s_setprio 1
KZ_L:
    ds_read_b96 v[124:126], v34 offset:4224
    ds_read_b128 v[120:123], v33 offset:3200
    ds_read_b64 v[16:17], v10 offset:0
    ds_read_b64 v[18:19], v10 offset:64
    ds_read_b64 v[20:21], v10 offset:512
    ds_read_b64 v[22:23], v10 offset:576
    ds_read_b64 v[24:25], v10 offset:1024
    ds_read_b64 v[26:27], v10 offset:1088
    ds_read_b64 v[28:29], v10 offset:1536
    ds_read_b64 v[30:31], v10 offset:1600
    v_add_u32 v10, 14448, v10
    s_waitcnt lgkmcnt(8)
    v_cmp_ne_u32 vcc, s47, v126
    s_cbranch_vccnz KZS1
KZS1R:
    v_cvt_pk_bf16_f32 v84, v120, v121
    v_cvt_pk_bf16_f32 v85, v122, v123
    s_nop 1
    v_mfma_f32_16x16x32_bf16 v[104:107], v[36:39], v[84:87], 0
    v_mfma_f32_16x16x32_bf16 v[108:111], v[42:45], v[84:87], 0
    v_mfma_f32_16x16x32_bf16 v[112:115], v[48:51], v[84:87], 0
    v_mfma_f32_16x16x32_bf16 v[116:119], v[54:57], v[84:87], 0
    s_waitcnt lgkmcnt(0)
    v_mfma_f32_16x16x32_bf16 v[92:95], v[16:19], v[128:131], 0
    v_mfma_f32_16x16x32_bf16 v[92:95], v[20:23], v[132:135], v[92:95]
    v_mfma_f32_16x16x32_bf16 v[92:95], v[24:27], v[136:139], v[92:95]
    v_mfma_f32_16x16x32_bf16 v[92:95], v[28:31], v[140:143], v[92:95]
    v_mul_f32 v5, v104, v104
    v_mul_f32 v6, v105, v105
    v_mul_f32 v7, v106, v106
    v_mul_f32 v90, v107, v107
    v_mfma_f32_16x16x32_bf16 v[104:107], v[60:63], v[84:87], 0
    v_mfma_f32_16x16x32_bf16 v[96:99], v[16:19], v[144:147], 0
    v_fmac_f32 v5, v108, v108
    v_fmac_f32 v6, v109, v109
    v_fmac_f32 v7, v110, v110
    v_fmac_f32 v90, v111, v111
    v_mfma_f32_16x16x32_bf16 v[108:111], v[66:69], v[84:87], 0
    v_mfma_f32_16x16x32_bf16 v[96:99], v[20:23], v[148:151], v[96:99]
    v_fmac_f32 v5, v112, v112
    v_fmac_f32 v6, v113, v113
    v_fmac_f32 v7, v114, v114
    v_fmac_f32 v90, v115, v115
    v_mfma_f32_16x16x32_bf16 v[112:115], v[72:75], v[84:87], 0
    v_mfma_f32_16x16x32_bf16 v[96:99], v[24:27], v[152:155], v[96:99]
    v_fmac_f32 v5, v116, v116
    v_fmac_f32 v6, v117, v117
    v_fmac_f32 v7, v118, v118
    v_fmac_f32 v90, v119, v119
    v_mfma_f32_16x16x32_bf16 v[116:119], v[78:81], v[84:87], 0
    v_mfma_f32_16x16x32_bf16 v[96:99], v[28:31], v[156:159], v[96:99]
    v_fmac_f32 v5, v104, v104
    v_fmac_f32 v6, v105, v105
    v_fmac_f32 v7, v106, v106
    v_fmac_f32 v90, v107, v107
    v_mfma_f32_16x16x32_bf16 v[100:103], v[16:19], v[160:163], 0
    v_mfma_f32_16x16x32_bf16 v[100:103], v[20:23], v[164:167], v[100:103]
    v_fmac_f32 v5, v108, v108
    v_fmac_f32 v6, v109, v109
    v_fmac_f32 v7, v110, v110
    v_fmac_f32 v90, v111, v111
    v_mfma_f32_16x16x32_bf16 v[100:103], v[24:27], v[168:171], v[100:103]
    v_mfma_f32_16x16x32_bf16 v[100:103], v[28:31], v[172:175], v[100:103]
    v_fmac_f32 v5, v112, v112
    v_fmac_f32 v6, v113, v113
    v_fmac_f32 v7, v114, v114
    v_fmac_f32 v90, v115, v115
    v_cvt_pk_bf16_f32 v40, v92, v93
    v_cvt_pk_bf16_f32 v41, v94, v95
    v_fmac_f32 v5, v116, v116
    v_fmac_f32 v6, v117, v117
    v_fmac_f32 v7, v118, v118
    v_fmac_f32 v90, v119, v119
    v_mfma_f32_16x16x32_bf16 v[92:95], v[16:19], v[176:179], 0
    v_mfma_f32_16x16x32_bf16 v[92:95], v[20:23], v[180:183], v[92:95]
    v_add_f32 v5, v5, v6
    v_add_f32 v7, v7, v90
    v_add_f32 v5, v5, v7
    v_mov_b32 v6, v5
    v_mfma_f32_16x16x32_bf16 v[92:95], v[24:27], v[184:187], v[92:95]
    v_mfma_f32_16x16x32_bf16 v[92:95], v[28:31], v[188:191], v[92:95]
    v_permlane16_swap_b32 v5, v6
    v_add_f32 v5, v5, v6
    v_mov_b32 v6, v5
    v_cvt_pk_bf16_f32 v46, v96, v97
    v_cvt_pk_bf16_f32 v47, v98, v99
    v_permlane32_swap_b32 v5, v6
    v_add_f32 v5, v5, v6
    v_mul_f32 v5, s69, v5
    v_fma_f32 v5, -v124, v124, v5
    v_mfma_f32_16x16x32_bf16 v[96:99], v[16:19], v[192:195], 0
    v_max_f32 v5, 0, v5
    v_add_f32 v5, s70, v5
    v_rsq_f32 v5, v5
    v_mfma_f32_16x16x32_bf16 v[96:99], v[20:23], v[196:199], v[96:99]
    v_mul_f32 v3, v125, v5
    v_mfma_f32_16x16x32_bf16 v[96:99], v[24:27], v[200:203], v[96:99]
    v_mfma_f32_16x16x32_bf16 v[96:99], v[28:31], v[204:207], v[96:99]
    v_max_f32_dpp v4, v3, v3 quad_perm:[1,0,3,2] row_mask:0xf bank_mask:0xf
    v_cvt_pk_bf16_f32 v52, v100, v101
    v_cvt_pk_bf16_f32 v53, v102, v103
    v_max_f32_dpp v4, v4, v4 quad_perm:[2,3,0,1] row_mask:0xf bank_mask:0xf
    v_mfma_f32_16x16x32_bf16 v[100:103], v[16:19], v[208:211], 0
    v_mfma_f32_16x16x32_bf16 v[100:103], v[20:23], v[212:215], v[100:103]
    v_max_f32_dpp v4, v4, v4 row_half_mirror row_mask:0xf bank_mask:0xf
    v_sub_f32 v3, v3, v4
    v_exp_f32 v3, v3
    v_mfma_f32_16x16x32_bf16 v[100:103], v[24:27], v[216:219], v[100:103]
    v_mfma_f32_16x16x32_bf16 v[100:103], v[28:31], v[220:223], v[100:103]
    v_add_f32_dpp v4, v3, v3 quad_perm:[1,0,3,2] row_mask:0xf bank_mask:0xf
    v_cvt_pk_bf16_f32 v58, v92, v93
    v_cvt_pk_bf16_f32 v59, v94, v95
    v_add_f32_dpp v4, v4, v4 quad_perm:[2,3,0,1] row_mask:0xf bank_mask:0xf
    v_mfma_f32_16x16x32_bf16 v[92:95], v[16:19], v[224:227], 0
    v_mfma_f32_16x16x32_bf16 v[92:95], v[20:23], v[228:231], v[92:95]
    v_add_f32_dpp v4, v4, v4 row_half_mirror row_mask:0xf bank_mask:0xf
    v_rcp_f32 v4, v4
    v_mfma_f32_16x16x32_bf16 v[92:95], v[24:27], v[232:235], v[92:95]
    v_mul_f32 v3, v3, v4
    v_mul_f32 v120, v120, v3
    v_mul_f32 v121, v121, v3
    v_mul_f32 v122, v122, v3
    v_mul_f32 v123, v123, v3
    v_cvt_pk_bf16_f32 v4, v3, v3
    ds_write_b16 v14, v4 offset:8
    v_add_f32_dpp v120, v120, v120 quad_perm:[1,0,3,2] row_mask:0xf bank_mask:0xf
    v_add_f32_dpp v121, v121, v121 quad_perm:[1,0,3,2] row_mask:0xf bank_mask:0xf
    v_add_f32_dpp v122, v122, v122 quad_perm:[1,0,3,2] row_mask:0xf bank_mask:0xf
    v_add_f32_dpp v123, v123, v123 quad_perm:[1,0,3,2] row_mask:0xf bank_mask:0xf
    v_add_f32_dpp v120, v120, v120 quad_perm:[2,3,0,1] row_mask:0xf bank_mask:0xf
    v_add_f32_dpp v121, v121, v121 quad_perm:[2,3,0,1] row_mask:0xf bank_mask:0xf
    v_add_f32_dpp v122, v122, v122 quad_perm:[2,3,0,1] row_mask:0xf bank_mask:0xf
    v_add_f32_dpp v123, v123, v123 quad_perm:[2,3,0,1] row_mask:0xf bank_mask:0xf
    v_add_f32_dpp v120, v120, v120 row_half_mirror row_mask:0xf bank_mask:0xf
    v_add_f32_dpp v121, v121, v121 row_half_mirror row_mask:0xf bank_mask:0xf
    v_add_f32_dpp v122, v122, v122 row_half_mirror row_mask:0xf bank_mask:0xf
    v_add_f32_dpp v123, v123, v123 row_half_mirror row_mask:0xf bank_mask:0xf
    v_cvt_pk_bf16_f32 v124, v120, v121
    v_cvt_pk_bf16_f32 v125, v122, v123
    ds_write_b64 v13, v[124:125] offset:0
    ds_read_b128 v[104:107], v15 offset:0
    ds_read_b128 v[108:111], v15 offset:64
    ds_read_b128 v[112:115], v15 offset:128
    ds_read_b128 v[116:119], v15 offset:192
    v_mfma_f32_16x16x32_bf16 v[92:95], v[28:31], v[236:239], v[92:95]
    v_cvt_pk_bf16_f32 v64, v96, v97
    s_waitcnt lgkmcnt(2)
    v_mfma_f32_16x16x32_bf16 v[120:123], v[36:39], v[104:107], 0
    v_mfma_f32_16x16x32_bf16 v[120:123], v[42:45], v[108:111], v[120:123]
    ds_read_b128 v[104:107], v15 offset:256
    ds_read_b128 v[108:111], v15 offset:320
    s_waitcnt lgkmcnt(2)
    v_mfma_f32_16x16x32_bf16 v[120:123], v[48:51], v[112:115], v[120:123]
    v_mfma_f32_16x16x32_bf16 v[120:123], v[54:57], v[116:119], v[120:123]
    ds_read_b128 v[112:115], v15 offset:384
    ds_read_b128 v[116:119], v15 offset:448
    s_waitcnt lgkmcnt(2)
    v_mfma_f32_16x16x32_bf16 v[120:123], v[60:63], v[104:107], v[120:123]
    v_mfma_f32_16x16x32_bf16 v[120:123], v[66:69], v[108:111], v[120:123]
    s_waitcnt lgkmcnt(0)
    v_mfma_f32_16x16x32_bf16 v[120:123], v[72:75], v[112:115], v[120:123]
    v_mfma_f32_16x16x32_bf16 v[120:123], v[78:81], v[116:119], v[120:123]
    ds_read_b64_tr_b16 v[38:39], v12 offset:0
    ds_read_b64_tr_b16 v[44:45], v12 offset:256
    ds_read_b64_tr_b16 v[50:51], v12 offset:512
    ds_read_b64_tr_b16 v[56:57], v12 offset:768
    ds_read_b64_tr_b16 v[62:63], v12 offset:1024
    ds_read_b64_tr_b16 v[68:69], v12 offset:1280
    ds_read_b64_tr_b16 v[74:75], v12 offset:1536
    ds_read_b64_tr_b16 v[80:81], v12 offset:1792
    v_add_u32 v12, 14448, v12
    v_cvt_pk_bf16_f32 v65, v98, v99
    v_mfma_f32_16x16x32_bf16 v[96:99], v[16:19], v[240:243], 0
    v_mfma_f32_16x16x32_bf16 v[96:99], v[20:23], v[244:247], v[96:99]
    v_mfma_f32_16x16x32_bf16 v[96:99], v[24:27], v[248:251], v[96:99]
    v_mfma_f32_16x16x32_bf16 v[96:99], v[28:31], v[252:255], v[96:99]
    v_cvt_pk_bf16_f32 v70, v100, v101
    v_cvt_pk_bf16_f32 v71, v102, v103
    v_cvt_pk_bf16_f32 v76, v92, v93
    v_cvt_pk_bf16_f32 v77, v94, v95
    s_nop 3
    v_cvt_pk_bf16_f32 v82, v96, v97
    v_cvt_pk_bf16_f32 v83, v98, v99
    v_cvt_pk_bf16_f32 v124, v120, v121
    v_cvt_pk_bf16_f32 v125, v122, v123
    buffer_store_dwordx2 v[124:125], v32, s[28:31], s68 offen
    s_add_u32 s68, s68, 2048
    ds_read_b96 v[124:126], v34 offset:5504
    ds_read_b128 v[120:123], v33 offset:4480
    ds_read_b64 v[16:17], v10 offset:0
    ds_read_b64 v[18:19], v10 offset:64
    ds_read_b64 v[20:21], v10 offset:512
    ds_read_b64 v[22:23], v10 offset:576
    ds_read_b64 v[24:25], v10 offset:1024
    ds_read_b64 v[26:27], v10 offset:1088
    ds_read_b64 v[28:29], v10 offset:1536
    ds_read_b64 v[30:31], v10 offset:1600
    v_add_u32 v10, 14448, v10
    s_waitcnt lgkmcnt(8)
    v_cmp_ne_u32 vcc, s47, v126
    s_cbranch_vccnz KZS2
KZS2R:
    v_cvt_pk_bf16_f32 v88, v120, v121
    v_cvt_pk_bf16_f32 v89, v122, v123
    s_nop 1
    v_mfma_f32_16x16x32_bf16 v[104:107], v[38:41], v[86:89], 0
    v_mfma_f32_16x16x32_bf16 v[108:111], v[44:47], v[86:89], 0
    v_mfma_f32_16x16x32_bf16 v[112:115], v[50:53], v[86:89], 0
    v_mfma_f32_16x16x32_bf16 v[116:119], v[56:59], v[86:89], 0
    s_waitcnt lgkmcnt(0)
    v_mfma_f32_16x16x32_bf16 v[92:95], v[16:19], v[128:131], 0
    v_mfma_f32_16x16x32_bf16 v[92:95], v[20:23], v[132:135], v[92:95]
    v_mfma_f32_16x16x32_bf16 v[92:95], v[24:27], v[136:139], v[92:95]
    v_mfma_f32_16x16x32_bf16 v[92:95], v[28:31], v[140:143], v[92:95]
    v_mul_f32 v5, v104, v104
    v_mul_f32 v6, v105, v105
    v_mul_f32 v7, v106, v106
    v_mul_f32 v90, v107, v107
    v_mfma_f32_16x16x32_bf16 v[104:107], v[62:65], v[86:89], 0
    v_mfma_f32_16x16x32_bf16 v[96:99], v[16:19], v[144:147], 0
    v_fmac_f32 v5, v108, v108
    v_fmac_f32 v6, v109, v109
    v_fmac_f32 v7, v110, v110
    v_fmac_f32 v90, v111, v111
    v_mfma_f32_16x16x32_bf16 v[108:111], v[68:71], v[86:89], 0
    v_mfma_f32_16x16x32_bf16 v[96:99], v[20:23], v[148:151], v[96:99]
    v_fmac_f32 v5, v112, v112
    v_fmac_f32 v6, v113, v113
    v_fmac_f32 v7, v114, v114
    v_fmac_f32 v90, v115, v115
    v_mfma_f32_16x16x32_bf16 v[112:115], v[74:77], v[86:89], 0
    v_mfma_f32_16x16x32_bf16 v[96:99], v[24:27], v[152:155], v[96:99]
    v_fmac_f32 v5, v116, v116
    v_fmac_f32 v6, v117, v117
    v_fmac_f32 v7, v118, v118
    v_fmac_f32 v90, v119, v119
    v_mfma_f32_16x16x32_bf16 v[116:119], v[80:83], v[86:89], 0
    v_mfma_f32_16x16x32_bf16 v[96:99], v[28:31], v[156:159], v[96:99]
    v_fmac_f32 v5, v104, v104
    v_fmac_f32 v6, v105, v105
    v_fmac_f32 v7, v106, v106
    v_fmac_f32 v90, v107, v107
    v_mfma_f32_16x16x32_bf16 v[100:103], v[16:19], v[160:163], 0
    v_mfma_f32_16x16x32_bf16 v[100:103], v[20:23], v[164:167], v[100:103]
    v_fmac_f32 v5, v108, v108
    v_fmac_f32 v6, v109, v109
    v_fmac_f32 v7, v110, v110
    v_fmac_f32 v90, v111, v111
    v_mfma_f32_16x16x32_bf16 v[100:103], v[24:27], v[168:171], v[100:103]
    v_mfma_f32_16x16x32_bf16 v[100:103], v[28:31], v[172:175], v[100:103]
    v_fmac_f32 v5, v112, v112
    v_fmac_f32 v6, v113, v113
    v_fmac_f32 v7, v114, v114
    v_fmac_f32 v90, v115, v115
    v_cvt_pk_bf16_f32 v36, v92, v93
    v_cvt_pk_bf16_f32 v37, v94, v95
    v_fmac_f32 v5, v116, v116
    v_fmac_f32 v6, v117, v117
    v_fmac_f32 v7, v118, v118
    v_fmac_f32 v90, v119, v119
    v_mfma_f32_16x16x32_bf16 v[92:95], v[16:19], v[176:179], 0
    v_mfma_f32_16x16x32_bf16 v[92:95], v[20:23], v[180:183], v[92:95]
    v_add_f32 v5, v5, v6
    v_add_f32 v7, v7, v90
    v_add_f32 v5, v5, v7
    v_mov_b32 v6, v5
    v_mfma_f32_16x16x32_bf16 v[92:95], v[24:27], v[184:187], v[92:95]
    v_mfma_f32_16x16x32_bf16 v[92:95], v[28:31], v[188:191], v[92:95]
    v_permlane16_swap_b32 v5, v6
    v_add_f32 v5, v5, v6
    v_mov_b32 v6, v5
    v_cvt_pk_bf16_f32 v42, v96, v97
    v_cvt_pk_bf16_f32 v43, v98, v99
    v_permlane32_swap_b32 v5, v6
    v_add_f32 v5, v5, v6
    v_mul_f32 v5, s69, v5
    v_fma_f32 v5, -v124, v124, v5
    v_mfma_f32_16x16x32_bf16 v[96:99], v[16:19], v[192:195], 0
    v_max_f32 v5, 0, v5
    v_add_f32 v5, s70, v5
    v_rsq_f32 v5, v5
    v_mfma_f32_16x16x32_bf16 v[96:99], v[20:23], v[196:199], v[96:99]
    v_mul_f32 v3, v125, v5
    v_mfma_f32_16x16x32_bf16 v[96:99], v[24:27], v[200:203], v[96:99]
    v_mfma_f32_16x16x32_bf16 v[96:99], v[28:31], v[204:207], v[96:99]
    v_max_f32_dpp v4, v3, v3 quad_perm:[1,0,3,2] row_mask:0xf bank_mask:0xf
    v_cvt_pk_bf16_f32 v48, v100, v101
    v_cvt_pk_bf16_f32 v49, v102, v103
    v_max_f32_dpp v4, v4, v4 quad_perm:[2,3,0,1] row_mask:0xf bank_mask:0xf
    v_mfma_f32_16x16x32_bf16 v[100:103], v[16:19], v[208:211], 0
    v_mfma_f32_16x16x32_bf16 v[100:103], v[20:23], v[212:215], v[100:103]
    v_max_f32_dpp v4, v4, v4 row_half_mirror row_mask:0xf bank_mask:0xf
    v_sub_f32 v3, v3, v4
    v_exp_f32 v3, v3
    v_mfma_f32_16x16x32_bf16 v[100:103], v[24:27], v[216:219], v[100:103]
    v_mfma_f32_16x16x32_bf16 v[100:103], v[28:31], v[220:223], v[100:103]
    v_add_f32_dpp v4, v3, v3 quad_perm:[1,0,3,2] row_mask:0xf bank_mask:0xf
    v_cvt_pk_bf16_f32 v54, v92, v93
    v_cvt_pk_bf16_f32 v55, v94, v95
    v_add_f32_dpp v4, v4, v4 quad_perm:[2,3,0,1] row_mask:0xf bank_mask:0xf
    v_mfma_f32_16x16x32_bf16 v[92:95], v[16:19], v[224:227], 0
    v_mfma_f32_16x16x32_bf16 v[92:95], v[20:23], v[228:231], v[92:95]
    v_add_f32_dpp v4, v4, v4 row_half_mirror row_mask:0xf bank_mask:0xf
    v_rcp_f32 v4, v4
    v_mfma_f32_16x16x32_bf16 v[92:95], v[24:27], v[232:235], v[92:95]
    v_mul_f32 v3, v3, v4
    v_mul_f32 v120, v120, v3
    v_mul_f32 v121, v121, v3
    v_mul_f32 v122, v122, v3
    v_mul_f32 v123, v123, v3
    v_cvt_pk_bf16_f32 v4, v3, v3
    ds_write_b16 v14, v4 offset:0
    v_add_f32_dpp v120, v120, v120 quad_perm:[1,0,3,2] row_mask:0xf bank_mask:0xf
    v_add_f32_dpp v121, v121, v121 quad_perm:[1,0,3,2] row_mask:0xf bank_mask:0xf
    v_add_f32_dpp v122, v122, v122 quad_perm:[1,0,3,2] row_mask:0xf bank_mask:0xf
    v_add_f32_dpp v123, v123, v123 quad_perm:[1,0,3,2] row_mask:0xf bank_mask:0xf
    v_add_f32_dpp v120, v120, v120 quad_perm:[2,3,0,1] row_mask:0xf bank_mask:0xf
    v_add_f32_dpp v121, v121, v121 quad_perm:[2,3,0,1] row_mask:0xf bank_mask:0xf
    v_add_f32_dpp v122, v122, v122 quad_perm:[2,3,0,1] row_mask:0xf bank_mask:0xf
    v_add_f32_dpp v123, v123, v123 quad_perm:[2,3,0,1] row_mask:0xf bank_mask:0xf
    v_add_f32_dpp v120, v120, v120 row_half_mirror row_mask:0xf bank_mask:0xf
    v_add_f32_dpp v121, v121, v121 row_half_mirror row_mask:0xf bank_mask:0xf
    v_add_f32_dpp v122, v122, v122 row_half_mirror row_mask:0xf bank_mask:0xf
    v_add_f32_dpp v123, v123, v123 row_half_mirror row_mask:0xf bank_mask:0xf
    v_cvt_pk_bf16_f32 v124, v120, v121
    v_cvt_pk_bf16_f32 v125, v122, v123
    ds_write_b64 v13, v[124:125] offset:8
    ds_read_b128 v[104:107], v15 offset:0
    ds_read_b128 v[108:111], v15 offset:64
    ds_read_b128 v[112:115], v15 offset:128
    ds_read_b128 v[116:119], v15 offset:192
    v_mfma_f32_16x16x32_bf16 v[92:95], v[28:31], v[236:239], v[92:95]
    v_cvt_pk_bf16_f32 v60, v96, v97
    s_waitcnt lgkmcnt(2)
    v_mfma_f32_16x16x32_bf16 v[120:123], v[38:41], v[104:107], 0
    v_mfma_f32_16x16x32_bf16 v[120:123], v[44:47], v[108:111], v[120:123]
    ds_read_b128 v[104:107], v15 offset:256
    ds_read_b128 v[108:111], v15 offset:320
    s_waitcnt lgkmcnt(2)
    v_mfma_f32_16x16x32_bf16 v[120:123], v[50:53], v[112:115], v[120:123]
    v_mfma_f32_16x16x32_bf16 v[120:123], v[56:59], v[116:119], v[120:123]
    ds_read_b128 v[112:115], v15 offset:384
    ds_read_b128 v[116:119], v15 offset:448
    s_waitcnt lgkmcnt(2)
    v_mfma_f32_16x16x32_bf16 v[120:123], v[62:65], v[104:107], v[120:123]
    v_mfma_f32_16x16x32_bf16 v[120:123], v[68:71], v[108:111], v[120:123]
    s_waitcnt lgkmcnt(0)
    v_mfma_f32_16x16x32_bf16 v[120:123], v[74:77], v[112:115], v[120:123]
    v_mfma_f32_16x16x32_bf16 v[120:123], v[80:83], v[116:119], v[120:123]
    ds_read_b64_tr_b16 v[38:39], v12 offset:0
    ds_read_b64_tr_b16 v[44:45], v12 offset:256
    ds_read_b64_tr_b16 v[50:51], v12 offset:512
    ds_read_b64_tr_b16 v[56:57], v12 offset:768
    ds_read_b64_tr_b16 v[62:63], v12 offset:1024
    ds_read_b64_tr_b16 v[68:69], v12 offset:1280
    ds_read_b64_tr_b16 v[74:75], v12 offset:1536
    ds_read_b64_tr_b16 v[80:81], v12 offset:1792
    v_add_u32 v12, 14448, v12
    v_cvt_pk_bf16_f32 v61, v98, v99
    v_mfma_f32_16x16x32_bf16 v[96:99], v[16:19], v[240:243], 0
    v_mfma_f32_16x16x32_bf16 v[96:99], v[20:23], v[244:247], v[96:99]
    v_mfma_f32_16x16x32_bf16 v[96:99], v[24:27], v[248:251], v[96:99]
    v_mfma_f32_16x16x32_bf16 v[96:99], v[28:31], v[252:255], v[96:99]
    v_cvt_pk_bf16_f32 v66, v100, v101
    v_cvt_pk_bf16_f32 v67, v102, v103
    v_cvt_pk_bf16_f32 v72, v92, v93
    v_cvt_pk_bf16_f32 v73, v94, v95
    s_nop 3
    v_cvt_pk_bf16_f32 v78, v96, v97
    v_cvt_pk_bf16_f32 v79, v98, v99
    v_cvt_pk_bf16_f32 v124, v120, v121
    v_cvt_pk_bf16_f32 v125, v122, v123
    buffer_store_dwordx2 v[124:125], v32, s[28:31], s68 offen
    s_add_u32 s68, s68, 2048
    v_add_u32 v33, 2560, v33
    v_add_u32 v34, 2560, v34
    s_add_u32 s66, s66, 2
    s_cmp_lt_u32 s66, 4
    s_cbranch_scc1 KZ_L
    ds_read_b96 v[124:126], v34 offset:4224
    ds_read_b128 v[120:123], v33 offset:3200
    s_waitcnt lgkmcnt(0)
    v_cmp_ne_u32 vcc, s47, v126
    s_cbranch_vccnz KZS3
KZS3R:
    v_cvt_pk_bf16_f32 v84, v120, v121
    v_cvt_pk_bf16_f32 v85, v122, v123
    s_nop 1
    v_mfma_f32_16x16x32_bf16 v[104:107], v[36:39], v[84:87], 0
    v_mfma_f32_16x16x32_bf16 v[108:111], v[42:45], v[84:87], 0
    v_mfma_f32_16x16x32_bf16 v[112:115], v[48:51], v[84:87], 0
    v_mfma_f32_16x16x32_bf16 v[116:119], v[54:57], v[84:87], 0
    s_waitcnt lgkmcnt(0)
    s_nop 3
    v_mul_f32 v5, v104, v104
    v_mul_f32 v6, v105, v105
    v_mul_f32 v7, v106, v106
    v_mul_f32 v90, v107, v107
    v_mfma_f32_16x16x32_bf16 v[104:107], v[60:63], v[84:87], 0
    v_fmac_f32 v5, v108, v108
    v_fmac_f32 v6, v109, v109
    v_fmac_f32 v7, v110, v110
    v_fmac_f32 v90, v111, v111
    v_mfma_f32_16x16x32_bf16 v[108:111], v[66:69], v[84:87], 0
    v_fmac_f32 v5, v112, v112
    v_fmac_f32 v6, v113, v113
    v_fmac_f32 v7, v114, v114
    v_fmac_f32 v90, v115, v115
    v_mfma_f32_16x16x32_bf16 v[112:115], v[72:75], v[84:87], 0
    v_fmac_f32 v5, v116, v116
    v_fmac_f32 v6, v117, v117
    v_fmac_f32 v7, v118, v118
    v_fmac_f32 v90, v119, v119
    v_mfma_f32_16x16x32_bf16 v[116:119], v[78:81], v[84:87], 0
    v_fmac_f32 v5, v104, v104
    v_fmac_f32 v6, v105, v105
    v_fmac_f32 v7, v106, v106
    v_fmac_f32 v90, v107, v107
    v_fmac_f32 v5, v108, v108
    v_fmac_f32 v6, v109, v109
    v_fmac_f32 v7, v110, v110
    v_fmac_f32 v90, v111, v111
    v_fmac_f32 v5, v112, v112
    v_fmac_f32 v6, v113, v113
    v_fmac_f32 v7, v114, v114
    v_fmac_f32 v90, v115, v115
    v_fmac_f32 v5, v116, v116
    v_fmac_f32 v6, v117, v117
    v_fmac_f32 v7, v118, v118
    v_fmac_f32 v90, v119, v119
    v_add_f32 v5, v5, v6
    v_add_f32 v7, v7, v90
    v_add_f32 v5, v5, v7
    v_mov_b32 v6, v5
    s_nop 1
    v_permlane16_swap_b32 v5, v6
    v_add_f32 v5, v5, v6
    v_mov_b32 v6, v5
    s_nop 1
    v_permlane32_swap_b32 v5, v6
    v_add_f32 v5, v5, v6
    v_mul_f32 v5, s69, v5
    v_fma_f32 v5, -v124, v124, v5
    v_max_f32 v5, 0, v5
    v_add_f32 v5, s70, v5
    v_rsq_f32 v5, v5
    s_nop 0
    v_mul_f32 v3, v125, v5
    s_nop 1
    v_max_f32_dpp v4, v3, v3 quad_perm:[1,0,3,2] row_mask:0xf bank_mask:0xf
    s_nop 1
    v_max_f32_dpp v4, v4, v4 quad_perm:[2,3,0,1] row_mask:0xf bank_mask:0xf
    s_nop 1
    v_max_f32_dpp v4, v4, v4 row_half_mirror row_mask:0xf bank_mask:0xf
    v_sub_f32 v3, v3, v4
    v_exp_f32 v3, v3
    s_nop 1
    v_add_f32_dpp v4, v3, v3 quad_perm:[1,0,3,2] row_mask:0xf bank_mask:0xf
    s_nop 1
    v_add_f32_dpp v4, v4, v4 quad_perm:[2,3,0,1] row_mask:0xf bank_mask:0xf
    s_nop 1
    v_add_f32_dpp v4, v4, v4 row_half_mirror row_mask:0xf bank_mask:0xf
    v_rcp_f32 v4, v4
    s_nop 0
    v_mul_f32 v3, v3, v4
    v_mul_f32 v120, v120, v3
    v_mul_f32 v121, v121, v3
    v_mul_f32 v122, v122, v3
    v_mul_f32 v123, v123, v3
    v_cvt_pk_bf16_f32 v4, v3, v3
    ds_write_b16 v14, v4 offset:8
    v_add_f32_dpp v120, v120, v120 quad_perm:[1,0,3,2] row_mask:0xf bank_mask:0xf
    v_add_f32_dpp v121, v121, v121 quad_perm:[1,0,3,2] row_mask:0xf bank_mask:0xf
    v_add_f32_dpp v122, v122, v122 quad_perm:[1,0,3,2] row_mask:0xf bank_mask:0xf
    v_add_f32_dpp v123, v123, v123 quad_perm:[1,0,3,2] row_mask:0xf bank_mask:0xf
    v_add_f32_dpp v120, v120, v120 quad_perm:[2,3,0,1] row_mask:0xf bank_mask:0xf
    v_add_f32_dpp v121, v121, v121 quad_perm:[2,3,0,1] row_mask:0xf bank_mask:0xf
    v_add_f32_dpp v122, v122, v122 quad_perm:[2,3,0,1] row_mask:0xf bank_mask:0xf
    v_add_f32_dpp v123, v123, v123 quad_perm:[2,3,0,1] row_mask:0xf bank_mask:0xf
    v_add_f32_dpp v120, v120, v120 row_half_mirror row_mask:0xf bank_mask:0xf
    v_add_f32_dpp v121, v121, v121 row_half_mirror row_mask:0xf bank_mask:0xf
    v_add_f32_dpp v122, v122, v122 row_half_mirror row_mask:0xf bank_mask:0xf
    v_add_f32_dpp v123, v123, v123 row_half_mirror row_mask:0xf bank_mask:0xf
    v_cvt_pk_bf16_f32 v124, v120, v121
    v_cvt_pk_bf16_f32 v125, v122, v123
    ds_write_b64 v13, v[124:125] offset:0
    ds_read_b128 v[104:107], v15 offset:0
    ds_read_b128 v[108:111], v15 offset:64
    ds_read_b128 v[112:115], v15 offset:128
    ds_read_b128 v[116:119], v15 offset:192
    s_waitcnt lgkmcnt(2)
    v_mfma_f32_16x16x32_bf16 v[120:123], v[36:39], v[104:107], 0
    v_mfma_f32_16x16x32_bf16 v[120:123], v[42:45], v[108:111], v[120:123]
    ds_read_b128 v[104:107], v15 offset:256
    ds_read_b128 v[108:111], v15 offset:320
    s_waitcnt lgkmcnt(2)
    v_mfma_f32_16x16x32_bf16 v[120:123], v[48:51], v[112:115], v[120:123]
    v_mfma_f32_16x16x32_bf16 v[120:123], v[54:57], v[116:119], v[120:123]
    ds_read_b128 v[112:115], v15 offset:384
    ds_read_b128 v[116:119], v15 offset:448
    s_waitcnt lgkmcnt(2)
    v_mfma_f32_16x16x32_bf16 v[120:123], v[60:63], v[104:107], v[120:123]
    v_mfma_f32_16x16x32_bf16 v[120:123], v[66:69], v[108:111], v[120:123]
    s_waitcnt lgkmcnt(0)
    v_mfma_f32_16x16x32_bf16 v[120:123], v[72:75], v[112:115], v[120:123]
    v_mfma_f32_16x16x32_bf16 v[120:123], v[78:81], v[116:119], v[120:123]
    s_nop 7
    v_cvt_pk_bf16_f32 v124, v120, v121
    v_cvt_pk_bf16_f32 v125, v122, v123
    buffer_store_dwordx2 v[124:125], v32, s[28:31], s68 offen
    s_add_u32 s68, s68, 2048
    s_branch K_FIN
KZS1:
    s_sleep 3
    ds_read_b96 v[124:126], v34 offset:4224
    ds_read_b128 v[120:123], v33 offset:3200
    s_sub_u32 s67, s67, 1
    s_cbranch_scc1 KZS1T
    s_waitcnt lgkmcnt(0)
    v_cmp_ne_u32 vcc, s47, v126
    s_cbranch_vccnz KZS1
    s_branch KZS1R
KZS1T:
    s_mov_b32 s67, 0
    s_waitcnt lgkmcnt(0)
    s_branch KZS1R
KZS2:
    s_sleep 3
    ds_read_b96 v[124:126], v34 offset:5504
    ds_read_b128 v[120:123], v33 offset:4480
    s_sub_u32 s67, s67, 1
    s_cbranch_scc1 KZS2T
    s_waitcnt lgkmcnt(0)
    v_cmp_ne_u32 vcc, s47, v126
    s_cbranch_vccnz KZS2
    s_branch KZS2R
KZS2T:
    s_mov_b32 s67, 0
    s_waitcnt lgkmcnt(0)
    s_branch KZS2R
KZS3:
    s_sleep 3
    ds_read_b96 v[124:126], v34 offset:4224
    ds_read_b128 v[120:123], v33 offset:3200
    s_sub_u32 s67, s67, 1
    s_cbranch_scc1 KZS3T
    s_waitcnt lgkmcnt(0)
    v_cmp_ne_u32 vcc, s47, v126
    s_cbranch_vccnz KZS3
    s_branch KZS3R
KZS3T:
    s_mov_b32 s67, 0
    s_waitcnt lgkmcnt(0)
    s_branch KZS3R
K_FIN:
    s_cmp_lg_u32 s2, 0
    s_cbranch_scc1 K_FIN2
    s_cmp_lg_u32 s36, 4
    s_cbranch_scc1 K_FIN2
    v_mov_b32 v4, s92
    v_mov_b32 v3, 0
    s_mov_b64 exec, 1
    buffer_store_dword v4, v3, s[8:11], 0 offen
K_FIN2:
K_END:
    s_endpgm
.section .rodata,"a"
.p2align 6
.amdhsa_kernel gather_scatter__hybrid_graph_tf_nagphormer__graph_kernel
  .amdhsa_next_free_vgpr 256
  .amdhsa_next_free_sgpr 100
  .amdhsa_accum_offset 256
  .amdhsa_group_segment_fixed_size 0
  .amdhsa_kernarg_size 96
  .amdhsa_user_sgpr_count 2
  .amdhsa_user_sgpr_kernarg_segment_ptr 1
  .amdhsa_system_sgpr_workgroup_id_x 1
.end_amdhsa_kernel
```
